```python
import torch

def _softmax(x, axis=-1):
    return torch.softmax(x, dim=axis)
def _gelu(x):
    return torch.nn.functional.gelu(x, approximate="tanh")
def _silu(x):
    return torch.nn.functional.silu(x)
def _sigmoid(x):
    return torch.sigmoid(x)
def _layernorm(x, axis=-1, eps=1e-5):
    m = x.mean(dim=axis, keepdim=True)
    v = x.var(dim=axis, keepdim=True, unbiased=False)
    return (x - m) / torch.sqrt(v + eps)
def _scatter_add(tgt, idx, src, axis=0):
    return tgt.clone().index_add_(axis, idx, src)
def _segment_sum(src, seg, n):
    out = torch.zeros((n,) + src.shape[1:], dtype=src.dtype)
    return out.index_add_(0, seg, src)
def _pad(x, pw):
    flat = tuple(v for pair in reversed(pw) for v in pair)
    return torch.nn.functional.pad(x, flat)

kernel_name = 'gated_mix__linear_attn_block__dense_activation_relu__prompt'

def setup_inputs():

    _w = (lambda a: (lambda t: t.to(torch.bfloat16) if t.is_floating_point() else t)(torch.as_tensor(a)))
    def _A_setup():
        B, S, D = 1, 2048, 512
        return {
            "x": _w((lambda *s: torch.randn(*s, dtype=torch.bfloat16) * 0.05)(B, S, D)),
            "wqkv": _w((lambda *s: torch.randn(*s, dtype=torch.bfloat16) * 0.8)(D, 3 * D)),
            "wo": _w((lambda *s: torch.randn(*s, dtype=torch.bfloat16) * 0.2)(D, D)),
        }
    _A_in = _A_setup()

    def _B_setup():
        B, S, D, Dff = 1, 2048, 512, 1376
        return {
            "x": _w((lambda *s: torch.randn(*s, dtype=torch.bfloat16) * 0.05)(B, S, D)),
            "w1": _w((lambda *s: torch.randn(*s, dtype=torch.bfloat16) * 0.05)(D, Dff)),
            "w2": _w((lambda *s: torch.randn(*s, dtype=torch.bfloat16) * 0.05)(Dff, D)),
        }
    _B_in = _B_setup()

    return {
        "A_x": _A_in["x"],
        "A_wqkv": _A_in["wqkv"],
        "A_wo": _A_in["wo"],
        "B_x": _B_in["x"],
        "B_w1": _B_in["w1"],
        "B_w2": _B_in["w2"],
        "gate_w": _w((lambda *s: torch.randn(*s, dtype=torch.bfloat16) * 0.05)(512) * 16.0),
    }

def reference(A_x, A_wqkv, A_wo, B_x, B_w1, B_w2, gate_w):
    def _A_ref(x, wqkv, wo):
        B, S, D = x.shape
        H = 32; Dh = D // H
        qkv = (lambda x, *d: x.permute(*d))((x @ wqkv).reshape(B, S, 3, H, Dh), 2, 0, 3, 1, 4)
        q, k, v = qkv[0], qkv[1], qkv[2]
        phi = lambda t: torch.where(t > 0, t + 1, torch.exp(t)) + 1e-6
        pq, pk = phi(q), phi(k)
        kv = torch.einsum("bhsd,bhse->bhde", pk, v)
        z = torch.einsum("bhsd->bhd", pk)
        num = torch.einsum("bhqd,bhde->bhqe", pq, kv)
        den = torch.einsum("bhqd,bhd->bhq", pq, z)[..., None] + 1e-6
        o = num / den
        return (lambda x, *d: x.permute(*d))(o, 0, 2, 1, 3).reshape(B, S, D) @ wo

    def _B_ref(x, w1, w2):
        h = torch.einsum("bsd,df->bsf", x, w1)
        zero = torch.zeros_like(h)
        h = torch.maximum(h, zero)
        return torch.einsum("bsf,fd->bsd", h, w2)

    x = A_x
    g = _sigmoid((x * gate_w).sum(-1, keepdims=True))
    a = _A_ref(x, A_wqkv, A_wo)
    b = _B_ref(x, B_w1, B_w2)
    return g * a + (1 - g) * b
```

```asm
; @launch grid=(256,1,1) block=(256,1,1) lds=163840
.amdgcn_target "amdgcn-amd-amdhsa--gfx950"
.text
.globl gated_mix__linear_attn_block__dense_activation_relu__prompt_kernel
.p2align 8
.type gated_mix__linear_attn_block__dense_activation_relu__prompt_kernel,@function
gated_mix__linear_attn_block__dense_activation_relu__prompt_kernel:
    s_lshr_b32 s50, s2, 7
    s_mul_i32 s76, s50, 24
    s_load_dwordx2 s[20:21], s[0:1], 0
    s_cmp_gt_u32 s50, 1
    s_cbranch_scc1 L_end
    s_load_dwordx2 s[24:25], s[0:1], s76 offset:8
    s_getpc_b64 s[74:75]
    s_lshl_b32 s77, s2, 7
    v_lshl_add_u32 v26, v0, 2, s77
    global_load_dword v72, v26, s[74:75]
    s_and_b32 s76, s2, 1
    s_lshl_b32 s51, s76, 2
    s_and_b32 s77, s2, 6
    s_xor_b32 s51, s51, s77
    s_bfe_u32 s78, s2, 0x30003
    s_lshl3_add_u32 s48, s76, s78
    s_lshr_b32 s79, s2, 6
    s_and_b32 s65, s79, 1
    s_add_u32 s49, s65, s77
    s_lshl2_add_u32 s80, s48, s79
    s_lshl_b32 s80, s80, 15
    s_and_b32 s81, s78, 2
    s_xor_b32 s81, s81, s51
    s_lshl_b32 s81, s81, 7
    s_add_u32 s80, s80, s81
    v_lshrrev_b32 v26, 3, v0
    v_and_b32 v27, 7, v0
    v_lshlrev_b32 v29, 5, v27
    v_lshl_add_u32 v28, v26, 10, v29
    v_add_u32 v28, s80, v28
    s_waitcnt lgkmcnt(0)
    global_load_dword v72, v28, s[20:21]
    s_load_dwordx2 s[10:11], s[0:1], 72
    s_load_dwordx2 s[28:29], s[0:1], 40
    s_load_dwordx2 s[32:33], s[0:1], 16
    s_load_dwordx4 s[16:19], s[0:1], 48
    v_mov_b32 v73, v0
    v_readfirstlane_b32 s3, v0
    v_and_b32 v0, 63, v0
    s_lshl2_add_u32 s76, s49, 32
    s_mul_i32 s77, s49, 11
    s_add_u32 s77, s77, s65
    s_movk_i32 s52, 3072
    s_movk_i32 s81, 1024
    s_cmp_eq_u32 s50, 0
    s_cselect_b32 s52, s52, 2752
    s_cselect_b32 s54, s76, s77
    s_lshl_b32 s54, s54, 5
    s_lshr_b32 s3, s3, 6
L_head_end:
    s_mov_b32 s22, 2097152
    s_mov_b32 s23, 0x20000
    s_mov_b32 s26, 1572864
    s_cmp_eq_u32 s50, 0
    s_cselect_b32 s26, s26, 1409024
    s_cselect_b32 s81, s81, 128
    s_mov_b32 s27, 0x20000
    v_lshrrev_b32 v26, 3, v0
    v_and_b32 v27, 7, v0
    v_lshrrev_b32 v28, 4, v0
    v_xor_b32 v29, v27, v28
    v_lshlrev_b32 v30, 10, v26
    v_lshl_add_u32 v2, v29, 4, v30
    v_xor_b32 v29, 4, v29
    v_lshl_add_u32 v3, v29, 4, v30
    v_add_u32 v3, 7168, v3
    v_add_u32 v4, 14336, v2
    v_add_u32 v5, 14336, v3
    s_lshl_b32 s53, s48, 17
    s_lshl_b32 s76, s3, 15
    s_add_u32 s53, s53, s76
    s_lshl_b32 s62, s3, 12
    s_lshl_b32 s89, s52, 6
    s_and_b32 s76, s78, 3
    s_xor_b32 s51, s51, s76
    s_bitcmp0_b32 s51, 0
    s_cselect_b32 s9, 1, -1
    s_mul_i32 s9, s9, s89
    s_lshl_b32 s76, s3, 4
    s_mul_i32 s61, s76, s52
    s_add_u32 s79, s54, 256
    s_add_u32 s54, s54, s61
    v_lshlrev_b32 v30, 1, v28
    v_xor_b32 v29, v27, v30
    v_lshlrev_b32 v29, 4, v29
    v_mad_u32_u24 v29, v28, s52, v29
    v_and_b32 v30, 1, v26
    v_mad_u32_u24 v6, v30, s81, v29
    v_xor_b32 v30, 1, v30
    v_mad_u32_u24 v8, v30, s81, v29
    s_lshl_b32 s76, s52, 2
    s_sub_u32 s76, s76, 1024
    s_lshl_b32 s77, s76, 1
    v_add_u32 v7, s76, v6
    v_add_u32 v8, s77, v8
    v_add_u32 v9, s76, v8
    s_add_u32 m0, s62, 0
    s_xor_b32 s80, s51, 0
    s_lshl_b32 s63, s80, 7
    s_add_u32 s63, s63, s53
    buffer_load_dwordx4 v2, s[20:23], s63 offen offset:0 lds
    buffer_load_dwordx4 v3, s[20:23], s63 offen offset:1024 lds
    buffer_load_dwordx4 v4, s[20:23], s63 offen offset:2048 lds
    buffer_load_dwordx4 v5, s[20:23], s63 offen offset:3072 lds
    s_add_u32 m0, s62, 49152
    s_mul_i32 s64, s80, s89
    s_add_u32 s64, s64, s54
    buffer_load_dwordx4 v6, s[24:27], s64 offen offset:0 lds
    buffer_load_dwordx4 v7, s[24:27], s64 offen offset:1024 lds
    buffer_load_dwordx4 v8, s[24:27], s64 offen offset:2048 lds
    buffer_load_dwordx4 v9, s[24:27], s64 offen offset:3072 lds
    s_lshl_b32 s76, s49, 2
    s_lshr_b32 s65, 0xb6a49280, s76
    s_and_b32 s65, s65, 15
    s_cmp_lt_u32 s65, 11
    s_cselect_b32 s76, s79, 1073741824
    s_lshl_b32 s77, s49, 7
    s_cmp_eq_u32 s50, 0
    s_cselect_b32 s76, s77, s76
    s_cselect_b32 s65, 0, s65
    s_add_u32 s61, s61, s76
    s_mov_b32 s30, 1409024
    s_mov_b32 s31, 0x20000
    s_mov_b32 s34, 524288
    s_mov_b32 s35, 0x20000
    s_waitcnt lgkmcnt(0)
    s_load_dword s59, s[10:11], 0
    s_mov_b32 s36, s10
    s_mov_b32 s37, s11
    s_mov_b32 s38, 0x10000000
    s_mov_b32 s39, 0x20000
    s_mov_b32 s40, s18
    s_mov_b32 s41, s19
    s_mov_b32 s42, 2097152
    s_mov_b32 s43, 0x20000
    s_lshr_b32 s57, s3, 1
    s_and_b32 s58, s3, 1
    s_and_b32 s55, s2, 7
    s_bfe_u32 s76, s2, 0x20003
    s_lshl2_add_u32 s55, s55, s76
    s_lshr_b32 s56, s2, 5
    s_lshl_b32 s56, s56, 2
    s_lshr_b32 s56, 0x32761054, s56
    s_and_b32 s56, s56, 7
    s_mov_b32 s72, 0xffff0000
    s_mov_b32 s73, 0xffff0000
    s_mov_b32 s90, 0x3fb8aa3b
    s_mov_b32 s91, 0x358637bd
    s_lshl_b32 s60, s3, 11
    v_lshlrev_b32 v24, 4, v0
    v_mul_u32_u24 v23, 43, v26
    v_and_b32 v23, 384, v23
    v_add_u32 v23, v23, v24
    v_lshlrev_b32 v25, 2, v0
    v_lshlrev_b32 v29, 1, v28
    v_xor_b32 v30, v27, v29
    v_lshlrev_b32 v30, 4, v30
    v_lshl_add_u32 v12, v26, 10, v30
    v_add_u32 v13, 7168, v12
    v_add_u32 v14, 14336, v12
    v_add_u32 v15, 21504, v12
    v_and_b32 v29, 2, v29
    v_xor_b32 v27, v27, v29
    s_cmp_ge_u32 s65, 8
    s_cselect_b32 s76, 4, 8
    s_lshl_b32 s77, s3, 5
    s_lshl_b32 s79, s52, 3
    s_cmp_eq_u32 s65, 11
    s_cselect_b64 s[74:75], -1, 0
    s_cselect_b32 s44, s16, s24
    s_cselect_b32 s45, s17, s25
    s_cselect_b32 s46, 1024, s26
    s_cselect_b32 s61, s77, s61
    s_cselect_b32 s4, 128, s89
    s_cselect_b32 s79, 16, s79
    s_mov_b32 s47, 0x20000
    v_mov_b32 v152, 1073741824
    v_and_b32 v153, 1, v26
    v_lshlrev_b32 v153, 1, v153
    v_and_b32 v154, 6, v26
    v_lshlrev_b32 v154, 1, v154
    v_cmp_gt_u32 vcc, s76, v27
    v_lshlrev_b32 v29, 4, v27
    v_mad_u32_u24 v29, v26, s52, v29
    v_cndmask_b32 v29, v152, v29, vcc
    v_cmp_eq_u32 vcc, v153, v27
    v_xor_b32 v27, 4, v27
    s_nop 0
    v_cndmask_b32 v30, v152, v154, vcc
    v_cndmask_b32 v10, v29, v30, s[74:75]
    v_cmp_gt_u32 vcc, s76, v27
    v_lshlrev_b32 v29, 4, v27
    v_mad_u32_u24 v29, v26, s52, v29
    v_cndmask_b32 v29, v152, v29, vcc
    v_cmp_eq_u32 vcc, v153, v27
    v_xor_b32 v27, 4, v27
    s_nop 0
    v_cndmask_b32 v30, v152, v154, vcc
    v_cndmask_b32 v11, v29, v30, s[74:75]
    v_add_u32 v11, s79, v11
    v_and_b32 v26, 15, v0
    v_lshrrev_b32 v27, 1, v26
    v_xor_b32 v27, v27, v28
    s_lshl_b32 s76, s57, 13
    v_lshl_add_u32 v26, v26, 7, s76
    v_lshl_add_u32 v144, v27, 4, v26
    v_xor_b32 v145, 64, v144
    v_bfe_u32 v26, v0, 2, 2
    v_and_b32 v27, 3, v0
    v_lshlrev_b32 v27, 3, v27
    v_lshl_add_u32 v30, v28, 3, v26
    v_bfe_u32 v29, v0, 2, 3
    s_lshl_b32 s76, s58, 1
    v_xor_b32 v152, s76, v29
    v_lshl_add_u32 v152, v152, 5, v27
    v_lshl_add_u32 v152, v30, 8, v152
    v_add_u32 v146, 49152, v152
    v_xor_b32 v147, 32, v146
    v_xor_b32 v148, 128, v146
    v_xor_b32 v149, 160, v146
    v_lshrrev_b32 v29, 1, v29
    v_xor_b32 v152, s76, v29
    v_lshl_add_u32 v152, v152, 5, v27
    v_lshl_add_u32 v152, v30, 7, v152
    v_add_u32 v150, 98304, v152
    v_xor_b32 v151, 32, v150
    v_lshl_add_u32 v152, v29, 5, v27
    v_lshrrev_b32 v30, 2, v0
    v_lshl_add_u32 v152, v30, 7, v152
    s_mul_i32 s12, s3, 24576
    s_cmp_eq_u32 s50, 0
    s_cselect_b32 s12, s12, s62
    v_add_u32 v16, s12, v152
    v_xor_b32 v17, 32, v16
    v_xor_b32 v18, 64, v16
    v_xor_b32 v19, 96, v16
    v_lshlrev_b32 v29, 7, v0
    s_lshl_b32 s71, s3, 15
    s_lshl_b32 s76, s56, 7
    s_add_u32 s71, s71, s76
    s_mul_i32 s16, s57, 294912
    s_add_u32 s16, s16, s71
    s_mul_i32 s17, s3, 327680
    s_add_u32 s17, s17, s71
    s_lshl1_add_u32 s76, s48, s57
    s_mul_i32 s66, s76, 362496
    s_add_u32 s66, s66, 16777216
    s_lshl_b32 s69, s76, 9
    s_lshl3_add_u32 s77, s58, s49
    s_lshl2_add_u32 s69, s77, s69
    s_lshl_b32 s85, s76, 9
    s_add_u32 s85, s85, 16384
    s_cmp_eq_u32 s50, 0
    s_cbranch_scc1 L_attn
    s_lshl2_add_u32 s76, s49, s58
    s_mul_i32 s76, s76, 3072
    s_add_u32 s82, s66, s76
    s_add_u32 s83, s82, 6144
    s_add_u32 s76, s65, s58
    s_add_u32 s76, s76, 32
    s_mul_i32 s76, s76, 3072
    s_add_u32 s84, s66, s76
    s_lshl2_add_u32 s77, s58, s65
    s_cmp_lt_u32 s77, 11
    s_cselect_b32 s84, s84, 1073741824
    s_cmp_eq_u32 s77, 11
    s_cselect_b32 s85, s85, 1073741824
    s_mul_i32 s14, s80, s4
    s_add_u32 s14, s14, s61
    s_add_u32 m0, s60, 98304
    s_nop 0
    buffer_load_dwordx4 v10, s[44:47], s14 offen lds
    s_add_u32 m0, s60, 99328
    s_nop 0
    buffer_load_dwordx4 v11, s[44:47], s14 offen lds
    s_add_u32 m0, s62, 16384
    s_xor_b32 s80, s51, 1
    s_lshl_b32 s63, s80, 7
    s_add_u32 s63, s63, s53
    buffer_load_dwordx4 v2, s[20:23], s63 offen offset:0 lds
    buffer_load_dwordx4 v3, s[20:23], s63 offen offset:1024 lds
    buffer_load_dwordx4 v4, s[20:23], s63 offen offset:2048 lds
    buffer_load_dwordx4 v5, s[20:23], s63 offen offset:3072 lds
    s_add_u32 m0, s62, 65536
    s_mul_i32 s64, s80, s89
    s_add_u32 s64, s64, s54
    buffer_load_dwordx4 v6, s[24:27], s64 offen offset:0 lds
    buffer_load_dwordx4 v7, s[24:27], s64 offen offset:1024 lds
    buffer_load_dwordx4 v8, s[24:27], s64 offen offset:2048 lds
    buffer_load_dwordx4 v9, s[24:27], s64 offen offset:3072 lds
    s_mul_i32 s14, s80, s4
    s_add_u32 s14, s14, s61
    s_add_u32 m0, s60, 106496
    s_nop 0
    buffer_load_dwordx4 v10, s[44:47], s14 offen lds
    s_add_u32 m0, s60, 107520
    s_nop 0
    buffer_load_dwordx4 v11, s[44:47], s14 offen lds
    s_waitcnt lgkmcnt(0)
    s_add_u32 s59, s59, 2654435769
    v_mov_b32 v1, s59
    s_waitcnt vmcnt(12)
    s_barrier
    ds_read_b128 a[0:3], v144 offset:0
    ds_read_b64_tr_b16 v[32:33], v146 offset:0
    ds_read_b128 a[16:19], v145 offset:0
    ds_read_b64_tr_b16 v[34:35], v146 offset:1024
    ds_read_b128 a[4:7], v144 offset:2048
    ds_read_b64_tr_b16 v[36:37], v146 offset:8192
    ds_read_b128 a[20:23], v145 offset:2048
    ds_read_b64_tr_b16 v[38:39], v146 offset:9216
    ds_read_b128 a[8:11], v144 offset:4096
    ds_read_b128 a[24:27], v145 offset:4096
    ds_read_b128 a[12:15], v144 offset:6144
    ds_read_b128 a[28:31], v145 offset:6144
    s_add_u32 m0, s62, 32768
    s_xor_b32 s80, s51, 2
    s_lshl_b32 s63, s80, 7
    s_add_u32 s63, s63, s53
    buffer_load_dwordx4 v2, s[20:23], s63 offen offset:0 lds
    buffer_load_dwordx4 v3, s[20:23], s63 offen offset:1024 lds
    buffer_load_dwordx4 v4, s[20:23], s63 offen offset:2048 lds
    buffer_load_dwordx4 v5, s[20:23], s63 offen offset:3072 lds
    s_mul_i32 s64, s80, s89
    s_add_u32 s64, s64, s54
    s_mul_i32 s14, s80, s4
    s_add_u32 s14, s14, s61
    s_waitcnt lgkmcnt(4)
    v_mfma_f32_16x16x32_bf16 v[160:163], v[32:35], a[0:3], 0
    ds_read_b64_tr_b16 v[40:41], v147 offset:0
    s_add_u32 m0, s62, 81920
    v_mfma_f32_16x16x32_bf16 v[160:163], v[36:39], a[16:19], v[160:163]
    ds_read_b64_tr_b16 v[42:43], v147 offset:1024
    buffer_load_dwordx4 v6, s[24:27], s64 offen offset:0 lds
    v_mfma_f32_16x16x32_bf16 v[168:171], v[36:39], a[20:23], 0
    ds_read_b64_tr_b16 v[44:45], v147 offset:8192
    s_xor_b32 s80, s51, 3
    v_mfma_f32_16x16x32_bf16 v[168:171], v[32:35], a[4:7], v[168:171]
    ds_read_b64_tr_b16 v[46:47], v147 offset:9216
    buffer_load_dwordx4 v7, s[24:27], s64 offen offset:1024 lds
    s_waitcnt lgkmcnt(6)
    v_mfma_f32_16x16x32_bf16 v[176:179], v[32:35], a[8:11], 0
    ds_read_b64_tr_b16 v[48:49], v148 offset:0
    s_lshl_b32 s63, s80, 7
    v_mfma_f32_16x16x32_bf16 v[176:179], v[36:39], a[24:27], v[176:179]
    ds_read_b64_tr_b16 v[50:51], v148 offset:1024
    s_add_u32 s63, s63, s53
    s_waitcnt lgkmcnt(6)
    v_mfma_f32_16x16x32_bf16 v[184:187], v[36:39], a[28:31], 0
    ds_read_b64_tr_b16 v[52:53], v148 offset:8192
    v_mfma_f32_16x16x32_bf16 v[184:187], v[32:35], a[12:15], v[184:187]
    ds_read_b64_tr_b16 v[54:55], v148 offset:9216
    buffer_load_dwordx4 v8, s[24:27], s64 offen offset:2048 lds
    s_waitcnt lgkmcnt(4)
    v_mfma_f32_16x16x32_bf16 v[188:191], v[40:43], a[12:15], 0
    ds_read_b64_tr_b16 v[56:57], v149 offset:0
    v_mfma_f32_16x16x32_bf16 v[188:191], v[44:47], a[28:31], v[188:191]
    ds_read_b64_tr_b16 v[58:59], v149 offset:1024
    buffer_load_dwordx4 v9, s[24:27], s64 offen offset:3072 lds
    v_mul_u32_u24 v74, 44, v73
    v_and_b32 v74, -4, v74
    s_and_b32 s77, s2, 127
    s_mul_i32 s76, s77, 11008
    buffer_load_dword v72, v74, s[28:31], s76 offen
    v_lshlrev_b32 v74, 4, v73
    s_lshl_b32 s76, s77, 12
    buffer_load_dword v72, v74, s[32:35], s76 offen
    s_lshl2_add_u32 s76, s2, s3
    s_lshl_b32 s76, s76, 7
    s_add_u32 s76, s76, 1769472
    v_mov_b32 v75, 0
    s_mov_b64 exec, 0x10001
    buffer_atomic_or v75, v25, s[36:39], s76 offen sc1
    s_mov_b64 exec, -1
    v_mfma_f32_16x16x32_bf16 v[180:183], v[44:47], a[24:27], 0
    ds_read_b64_tr_b16 v[60:61], v149 offset:8192
    s_add_u32 m0, s60, 114688
    v_mfma_f32_16x16x32_bf16 v[180:183], v[40:43], a[8:11], v[180:183]
    ds_read_b64_tr_b16 v[62:63], v149 offset:9216
    buffer_load_dwordx4 v10, s[44:47], s14 offen lds
    v_mfma_f32_16x16x32_bf16 v[172:175], v[40:43], a[4:7], 0
    v_mfma_f32_16x16x32_bf16 v[172:175], v[44:47], a[20:23], v[172:175]
    v_mfma_f32_16x16x32_bf16 v[164:167], v[44:47], a[16:19], 0
    s_add_u32 m0, s60, 115712
    v_mfma_f32_16x16x32_bf16 v[164:167], v[40:43], a[0:3], v[164:167]
    buffer_load_dwordx4 v11, s[44:47], s14 offen lds
    s_waitcnt vmcnt(13) lgkmcnt(0)
    s_barrier
    v_mfma_f32_16x16x32_bf16 v[192:195], v[48:51], a[0:3], 0
    ds_read_b128 a[32:35], v144 offset:16384
    s_add_u32 m0, s62, 0
    v_mfma_f32_16x16x32_bf16 v[192:195], v[52:55], a[16:19], v[192:195]
    ds_read_b64_tr_b16 v[32:33], v146 offset:16384
    buffer_load_dwordx4 v2, s[20:23], s63 offen offset:0 lds
    v_mfma_f32_16x16x32_bf16 v[200:203], v[52:55], a[20:23], 0
    ds_read_b128 a[48:51], v145 offset:16384
    s_mul_i32 s64, s80, s89
    v_mfma_f32_16x16x32_bf16 v[200:203], v[48:51], a[4:7], v[200:203]
    ds_read_b64_tr_b16 v[34:35], v146 offset:17408
    s_add_u32 s64, s64, s54
    v_mfma_f32_16x16x32_bf16 v[208:211], v[48:51], a[8:11], 0
    ds_read_b128 a[36:39], v144 offset:18432
    s_mul_i32 s14, s80, s4
    v_mfma_f32_16x16x32_bf16 v[208:211], v[52:55], a[24:27], v[208:211]
    ds_read_b64_tr_b16 v[36:37], v146 offset:24576
    buffer_load_dwordx4 v3, s[20:23], s63 offen offset:1024 lds
    v_mfma_f32_16x16x32_bf16 v[216:219], v[52:55], a[28:31], 0
    ds_read_b128 a[52:55], v145 offset:18432
    s_add_u32 s14, s14, s61
    v_mfma_f32_16x16x32_bf16 v[216:219], v[48:51], a[12:15], v[216:219]
    ds_read_b64_tr_b16 v[38:39], v146 offset:25600
    v_mfma_f32_16x16x32_bf16 v[220:223], v[56:59], a[12:15], 0
    ds_read_b128 a[40:43], v144 offset:20480
    v_mfma_f32_16x16x32_bf16 v[220:223], v[60:63], a[28:31], v[220:223]
    buffer_load_dwordx4 v4, s[20:23], s63 offen offset:2048 lds
    v_mfma_f32_16x16x32_bf16 v[212:215], v[60:63], a[24:27], 0
    ds_read_b128 a[56:59], v145 offset:20480
    v_mfma_f32_16x16x32_bf16 v[212:215], v[56:59], a[8:11], v[212:215]
    v_mfma_f32_16x16x32_bf16 v[204:207], v[56:59], a[4:7], 0
    ds_read_b128 a[44:47], v144 offset:22528
    v_mfma_f32_16x16x32_bf16 v[204:207], v[60:63], a[20:23], v[204:207]
    buffer_load_dwordx4 v5, s[20:23], s63 offen offset:3072 lds
    v_mfma_f32_16x16x32_bf16 v[196:199], v[60:63], a[16:19], 0
    ds_read_b128 a[60:63], v145 offset:22528
    v_mfma_f32_16x16x32_bf16 v[196:199], v[56:59], a[0:3], v[196:199]
    s_waitcnt lgkmcnt(4)
    v_mfma_f32_16x16x32_bf16 v[160:163], v[32:35], a[32:35], v[160:163]
    ds_read_b64_tr_b16 v[40:41], v147 offset:16384
    s_add_u32 m0, s62, 49152
    v_mfma_f32_16x16x32_bf16 v[160:163], v[36:39], a[48:51], v[160:163]
    ds_read_b64_tr_b16 v[42:43], v147 offset:17408
    buffer_load_dwordx4 v6, s[24:27], s64 offen offset:0 lds
    v_mfma_f32_16x16x32_bf16 v[168:171], v[36:39], a[52:55], v[168:171]
    ds_read_b64_tr_b16 v[44:45], v147 offset:24576
    s_xor_b32 s80, s51, 4
    v_mfma_f32_16x16x32_bf16 v[168:171], v[32:35], a[36:39], v[168:171]
    ds_read_b64_tr_b16 v[46:47], v147 offset:25600
    buffer_load_dwordx4 v7, s[24:27], s64 offen offset:1024 lds
    s_waitcnt lgkmcnt(6)
    v_mfma_f32_16x16x32_bf16 v[176:179], v[32:35], a[40:43], v[176:179]
    ds_read_b64_tr_b16 v[48:49], v148 offset:16384
    s_lshl_b32 s63, s80, 7
    v_mfma_f32_16x16x32_bf16 v[176:179], v[36:39], a[56:59], v[176:179]
    ds_read_b64_tr_b16 v[50:51], v148 offset:17408
    s_add_u32 s63, s63, s53
    s_waitcnt lgkmcnt(6)
    v_mfma_f32_16x16x32_bf16 v[184:187], v[36:39], a[60:63], v[184:187]
    ds_read_b64_tr_b16 v[52:53], v148 offset:24576
    v_mfma_f32_16x16x32_bf16 v[184:187], v[32:35], a[44:47], v[184:187]
    ds_read_b64_tr_b16 v[54:55], v148 offset:25600
    buffer_load_dwordx4 v8, s[24:27], s64 offen offset:2048 lds
    s_waitcnt lgkmcnt(4)
    v_mfma_f32_16x16x32_bf16 v[188:191], v[40:43], a[44:47], v[188:191]
    ds_read_b64_tr_b16 v[56:57], v149 offset:16384
    v_mfma_f32_16x16x32_bf16 v[188:191], v[44:47], a[60:63], v[188:191]
    ds_read_b64_tr_b16 v[58:59], v149 offset:17408
    buffer_load_dwordx4 v9, s[24:27], s64 offen offset:3072 lds
    v_mfma_f32_16x16x32_bf16 v[180:183], v[44:47], a[56:59], v[180:183]
    ds_read_b64_tr_b16 v[60:61], v149 offset:24576
    s_add_u32 m0, s60, 122880
    v_mfma_f32_16x16x32_bf16 v[180:183], v[40:43], a[40:43], v[180:183]
    ds_read_b64_tr_b16 v[62:63], v149 offset:25600
    buffer_load_dwordx4 v10, s[44:47], s14 offen lds
    v_mfma_f32_16x16x32_bf16 v[172:175], v[40:43], a[36:39], v[172:175]
    v_mfma_f32_16x16x32_bf16 v[172:175], v[44:47], a[52:55], v[172:175]
    v_mfma_f32_16x16x32_bf16 v[164:167], v[44:47], a[48:51], v[164:167]
    s_add_u32 m0, s60, 123904
    v_mfma_f32_16x16x32_bf16 v[164:167], v[40:43], a[32:35], v[164:167]
    buffer_load_dwordx4 v11, s[44:47], s14 offen lds
    s_waitcnt vmcnt(10) lgkmcnt(0)
    s_barrier
    v_mfma_f32_16x16x32_bf16 v[192:195], v[48:51], a[32:35], v[192:195]
    ds_read_b128 a[64:67], v144 offset:32768
    s_add_u32 m0, s62, 16384
    v_mfma_f32_16x16x32_bf16 v[192:195], v[52:55], a[48:51], v[192:195]
    ds_read_b64_tr_b16 v[32:33], v146 offset:32768
    buffer_load_dwordx4 v2, s[20:23], s63 offen offset:0 lds
    v_mfma_f32_16x16x32_bf16 v[200:203], v[52:55], a[52:55], v[200:203]
    ds_read_b128 a[80:83], v145 offset:32768
    s_mul_i32 s64, s80, s89
    v_mfma_f32_16x16x32_bf16 v[200:203], v[48:51], a[36:39], v[200:203]
    ds_read_b64_tr_b16 v[34:35], v146 offset:33792
    s_add_u32 s64, s64, s54
    v_mfma_f32_16x16x32_bf16 v[208:211], v[48:51], a[40:43], v[208:211]
    ds_read_b128 a[68:71], v144 offset:34816
    s_mul_i32 s14, s80, s4
    v_mfma_f32_16x16x32_bf16 v[208:211], v[52:55], a[56:59], v[208:211]
    ds_read_b64_tr_b16 v[36:37], v146 offset:40960
    buffer_load_dwordx4 v3, s[20:23], s63 offen offset:1024 lds
    v_mfma_f32_16x16x32_bf16 v[216:219], v[52:55], a[60:63], v[216:219]
    ds_read_b128 a[84:87], v145 offset:34816
    s_add_u32 s14, s14, s61
    v_mfma_f32_16x16x32_bf16 v[216:219], v[48:51], a[44:47], v[216:219]
    ds_read_b64_tr_b16 v[38:39], v146 offset:41984
    v_mfma_f32_16x16x32_bf16 v[220:223], v[56:59], a[44:47], v[220:223]
    ds_read_b128 a[72:75], v144 offset:36864
    v_mfma_f32_16x16x32_bf16 v[220:223], v[60:63], a[60:63], v[220:223]
    buffer_load_dwordx4 v4, s[20:23], s63 offen offset:2048 lds
    v_mfma_f32_16x16x32_bf16 v[212:215], v[60:63], a[56:59], v[212:215]
    ds_read_b128 a[88:91], v145 offset:36864
    v_mfma_f32_16x16x32_bf16 v[212:215], v[56:59], a[40:43], v[212:215]
    v_mfma_f32_16x16x32_bf16 v[204:207], v[56:59], a[36:39], v[204:207]
    ds_read_b128 a[76:79], v144 offset:38912
    v_mfma_f32_16x16x32_bf16 v[204:207], v[60:63], a[52:55], v[204:207]
    buffer_load_dwordx4 v5, s[20:23], s63 offen offset:3072 lds
    v_mfma_f32_16x16x32_bf16 v[196:199], v[60:63], a[48:51], v[196:199]
    ds_read_b128 a[92:95], v145 offset:38912
    v_mfma_f32_16x16x32_bf16 v[196:199], v[56:59], a[32:35], v[196:199]
    s_waitcnt lgkmcnt(4)
    v_mfma_f32_16x16x32_bf16 v[160:163], v[32:35], a[64:67], v[160:163]
    ds_read_b64_tr_b16 v[40:41], v147 offset:32768
    s_add_u32 m0, s62, 65536
    v_mfma_f32_16x16x32_bf16 v[160:163], v[36:39], a[80:83], v[160:163]
    ds_read_b64_tr_b16 v[42:43], v147 offset:33792
    buffer_load_dwordx4 v6, s[24:27], s64 offen offset:0 lds
    v_mfma_f32_16x16x32_bf16 v[168:171], v[36:39], a[84:87], v[168:171]
    ds_read_b64_tr_b16 v[44:45], v147 offset:40960
    s_xor_b32 s80, s51, 5
    v_mfma_f32_16x16x32_bf16 v[168:171], v[32:35], a[68:71], v[168:171]
    ds_read_b64_tr_b16 v[46:47], v147 offset:41984
    buffer_load_dwordx4 v7, s[24:27], s64 offen offset:1024 lds
    s_waitcnt lgkmcnt(6)
    v_mfma_f32_16x16x32_bf16 v[176:179], v[32:35], a[72:75], v[176:179]
    ds_read_b64_tr_b16 v[48:49], v148 offset:32768
    s_lshl_b32 s63, s80, 7
    v_mfma_f32_16x16x32_bf16 v[176:179], v[36:39], a[88:91], v[176:179]
    ds_read_b64_tr_b16 v[50:51], v148 offset:33792
    s_add_u32 s63, s63, s53
    s_waitcnt lgkmcnt(6)
    v_mfma_f32_16x16x32_bf16 v[184:187], v[36:39], a[92:95], v[184:187]
    ds_read_b64_tr_b16 v[52:53], v148 offset:40960
    v_mfma_f32_16x16x32_bf16 v[184:187], v[32:35], a[76:79], v[184:187]
    ds_read_b64_tr_b16 v[54:55], v148 offset:41984
    buffer_load_dwordx4 v8, s[24:27], s64 offen offset:2048 lds
    s_waitcnt lgkmcnt(4)
    v_mfma_f32_16x16x32_bf16 v[188:191], v[40:43], a[76:79], v[188:191]
    ds_read_b64_tr_b16 v[56:57], v149 offset:32768
    v_mfma_f32_16x16x32_bf16 v[188:191], v[44:47], a[92:95], v[188:191]
    ds_read_b64_tr_b16 v[58:59], v149 offset:33792
    buffer_load_dwordx4 v9, s[24:27], s64 offen offset:3072 lds
    v_mfma_f32_16x16x32_bf16 v[180:183], v[44:47], a[88:91], v[180:183]
    ds_read_b64_tr_b16 v[60:61], v149 offset:40960
    s_add_u32 m0, s60, 131072
    v_mfma_f32_16x16x32_bf16 v[180:183], v[40:43], a[72:75], v[180:183]
    ds_read_b64_tr_b16 v[62:63], v149 offset:41984
    buffer_load_dwordx4 v10, s[44:47], s14 offen lds
    v_mfma_f32_16x16x32_bf16 v[172:175], v[40:43], a[68:71], v[172:175]
    v_mfma_f32_16x16x32_bf16 v[172:175], v[44:47], a[84:87], v[172:175]
    v_mfma_f32_16x16x32_bf16 v[164:167], v[44:47], a[80:83], v[164:167]
    s_add_u32 m0, s60, 132096
    v_mfma_f32_16x16x32_bf16 v[164:167], v[40:43], a[64:67], v[164:167]
    buffer_load_dwordx4 v11, s[44:47], s14 offen lds
    s_waitcnt vmcnt(10) lgkmcnt(0)
    s_barrier
    v_mfma_f32_16x16x32_bf16 v[192:195], v[48:51], a[64:67], v[192:195]
    ds_read_b128 a[96:99], v144 offset:0
    s_add_u32 m0, s62, 32768
    v_mfma_f32_16x16x32_bf16 v[192:195], v[52:55], a[80:83], v[192:195]
    ds_read_b64_tr_b16 v[32:33], v146 offset:0
    buffer_load_dwordx4 v2, s[20:23], s63 offen offset:0 lds
    v_mfma_f32_16x16x32_bf16 v[200:203], v[52:55], a[84:87], v[200:203]
    ds_read_b128 a[112:115], v145 offset:0
    s_mul_i32 s64, s80, s89
    v_mfma_f32_16x16x32_bf16 v[200:203], v[48:51], a[68:71], v[200:203]
    ds_read_b64_tr_b16 v[34:35], v146 offset:1024
    s_add_u32 s64, s64, s54
    v_mfma_f32_16x16x32_bf16 v[208:211], v[48:51], a[72:75], v[208:211]
    ds_read_b128 a[100:103], v144 offset:2048
    s_mul_i32 s14, s80, s4
    v_mfma_f32_16x16x32_bf16 v[208:211], v[52:55], a[88:91], v[208:211]
    ds_read_b64_tr_b16 v[36:37], v146 offset:8192
    buffer_load_dwordx4 v3, s[20:23], s63 offen offset:1024 lds
    v_mfma_f32_16x16x32_bf16 v[216:219], v[52:55], a[92:95], v[216:219]
    ds_read_b128 a[116:119], v145 offset:2048
    s_add_u32 s14, s14, s61
    v_mfma_f32_16x16x32_bf16 v[216:219], v[48:51], a[76:79], v[216:219]
    ds_read_b64_tr_b16 v[38:39], v146 offset:9216
    v_mfma_f32_16x16x32_bf16 v[220:223], v[56:59], a[76:79], v[220:223]
    ds_read_b128 a[104:107], v144 offset:4096
    v_mfma_f32_16x16x32_bf16 v[220:223], v[60:63], a[92:95], v[220:223]
    buffer_load_dwordx4 v4, s[20:23], s63 offen offset:2048 lds
    v_mfma_f32_16x16x32_bf16 v[212:215], v[60:63], a[88:91], v[212:215]
    ds_read_b128 a[120:123], v145 offset:4096
    v_mfma_f32_16x16x32_bf16 v[212:215], v[56:59], a[72:75], v[212:215]
    v_mfma_f32_16x16x32_bf16 v[204:207], v[56:59], a[68:71], v[204:207]
    ds_read_b128 a[108:111], v144 offset:6144
    v_mfma_f32_16x16x32_bf16 v[204:207], v[60:63], a[84:87], v[204:207]
    buffer_load_dwordx4 v5, s[20:23], s63 offen offset:3072 lds
    v_mfma_f32_16x16x32_bf16 v[196:199], v[60:63], a[80:83], v[196:199]
    ds_read_b128 a[124:127], v145 offset:6144
    v_mfma_f32_16x16x32_bf16 v[196:199], v[56:59], a[64:67], v[196:199]
    s_waitcnt lgkmcnt(4)
    v_mfma_f32_16x16x32_bf16 v[160:163], v[32:35], a[96:99], v[160:163]
    ds_read_b64_tr_b16 v[40:41], v147 offset:0
    s_add_u32 m0, s62, 81920
    v_mfma_f32_16x16x32_bf16 v[160:163], v[36:39], a[112:115], v[160:163]
    ds_read_b64_tr_b16 v[42:43], v147 offset:1024
    buffer_load_dwordx4 v6, s[24:27], s64 offen offset:0 lds
    v_mfma_f32_16x16x32_bf16 v[168:171], v[36:39], a[116:119], v[168:171]
    ds_read_b64_tr_b16 v[44:45], v147 offset:8192
    s_xor_b32 s80, s51, 6
    v_mfma_f32_16x16x32_bf16 v[168:171], v[32:35], a[100:103], v[168:171]
    ds_read_b64_tr_b16 v[46:47], v147 offset:9216
    buffer_load_dwordx4 v7, s[24:27], s64 offen offset:1024 lds
    s_waitcnt lgkmcnt(6)
    v_mfma_f32_16x16x32_bf16 v[176:179], v[32:35], a[104:107], v[176:179]
    ds_read_b64_tr_b16 v[48:49], v148 offset:0
    s_lshl_b32 s63, s80, 7
    v_mfma_f32_16x16x32_bf16 v[176:179], v[36:39], a[120:123], v[176:179]
    ds_read_b64_tr_b16 v[50:51], v148 offset:1024
    s_add_u32 s63, s63, s53
    s_waitcnt lgkmcnt(6)
    v_mfma_f32_16x16x32_bf16 v[184:187], v[36:39], a[124:127], v[184:187]
    ds_read_b64_tr_b16 v[52:53], v148 offset:8192
    v_mfma_f32_16x16x32_bf16 v[184:187], v[32:35], a[108:111], v[184:187]
    ds_read_b64_tr_b16 v[54:55], v148 offset:9216
    buffer_load_dwordx4 v8, s[24:27], s64 offen offset:2048 lds
    s_waitcnt lgkmcnt(4)
    v_mfma_f32_16x16x32_bf16 v[188:191], v[40:43], a[108:111], v[188:191]
    ds_read_b64_tr_b16 v[56:57], v149 offset:0
    v_mfma_f32_16x16x32_bf16 v[188:191], v[44:47], a[124:127], v[188:191]
    ds_read_b64_tr_b16 v[58:59], v149 offset:1024
    buffer_load_dwordx4 v9, s[24:27], s64 offen offset:3072 lds
    v_mfma_f32_16x16x32_bf16 v[180:183], v[44:47], a[120:123], v[180:183]
    ds_read_b64_tr_b16 v[60:61], v149 offset:8192
    s_add_u32 m0, s60, 139264
    v_mfma_f32_16x16x32_bf16 v[180:183], v[40:43], a[104:107], v[180:183]
    ds_read_b64_tr_b16 v[62:63], v149 offset:9216
    buffer_load_dwordx4 v10, s[44:47], s14 offen lds
    v_mfma_f32_16x16x32_bf16 v[172:175], v[40:43], a[100:103], v[172:175]
    v_mfma_f32_16x16x32_bf16 v[172:175], v[44:47], a[116:119], v[172:175]
    v_mfma_f32_16x16x32_bf16 v[164:167], v[44:47], a[112:115], v[164:167]
    s_add_u32 m0, s60, 140288
    v_mfma_f32_16x16x32_bf16 v[164:167], v[40:43], a[96:99], v[164:167]
    buffer_load_dwordx4 v11, s[44:47], s14 offen lds
    s_waitcnt vmcnt(10) lgkmcnt(0)
    s_barrier
    v_mfma_f32_16x16x32_bf16 v[192:195], v[48:51], a[96:99], v[192:195]
    ds_read_b128 a[128:131], v144 offset:16384
    s_add_u32 m0, s62, 0
    v_mfma_f32_16x16x32_bf16 v[192:195], v[52:55], a[112:115], v[192:195]
    ds_read_b64_tr_b16 v[32:33], v146 offset:16384
    buffer_load_dwordx4 v2, s[20:23], s63 offen offset:0 lds
    v_mfma_f32_16x16x32_bf16 v[200:203], v[52:55], a[116:119], v[200:203]
    ds_read_b128 a[144:147], v145 offset:16384
    s_mul_i32 s64, s80, s89
    v_mfma_f32_16x16x32_bf16 v[200:203], v[48:51], a[100:103], v[200:203]
    ds_read_b64_tr_b16 v[34:35], v146 offset:17408
    s_add_u32 s64, s64, s54
    v_mfma_f32_16x16x32_bf16 v[208:211], v[48:51], a[104:107], v[208:211]
    ds_read_b128 a[132:135], v144 offset:18432
    s_mul_i32 s14, s80, s4
    v_mfma_f32_16x16x32_bf16 v[208:211], v[52:55], a[120:123], v[208:211]
    ds_read_b64_tr_b16 v[36:37], v146 offset:24576
    buffer_load_dwordx4 v3, s[20:23], s63 offen offset:1024 lds
    v_mfma_f32_16x16x32_bf16 v[216:219], v[52:55], a[124:127], v[216:219]
    ds_read_b128 a[148:151], v145 offset:18432
    s_add_u32 s14, s14, s61
    v_mfma_f32_16x16x32_bf16 v[216:219], v[48:51], a[108:111], v[216:219]
    ds_read_b64_tr_b16 v[38:39], v146 offset:25600
    v_mfma_f32_16x16x32_bf16 v[220:223], v[56:59], a[108:111], v[220:223]
    ds_read_b128 a[136:139], v144 offset:20480
    v_mfma_f32_16x16x32_bf16 v[220:223], v[60:63], a[124:127], v[220:223]
    buffer_load_dwordx4 v4, s[20:23], s63 offen offset:2048 lds
    v_mfma_f32_16x16x32_bf16 v[212:215], v[60:63], a[120:123], v[212:215]
    ds_read_b128 a[152:155], v145 offset:20480
    v_mfma_f32_16x16x32_bf16 v[212:215], v[56:59], a[104:107], v[212:215]
    v_mfma_f32_16x16x32_bf16 v[204:207], v[56:59], a[100:103], v[204:207]
    ds_read_b128 a[140:143], v144 offset:22528
    v_mfma_f32_16x16x32_bf16 v[204:207], v[60:63], a[116:119], v[204:207]
    buffer_load_dwordx4 v5, s[20:23], s63 offen offset:3072 lds
    v_mfma_f32_16x16x32_bf16 v[196:199], v[60:63], a[112:115], v[196:199]
    ds_read_b128 a[156:159], v145 offset:22528
    v_mfma_f32_16x16x32_bf16 v[196:199], v[56:59], a[96:99], v[196:199]
    s_waitcnt lgkmcnt(4)
    v_mfma_f32_16x16x32_bf16 v[160:163], v[32:35], a[128:131], v[160:163]
    ds_read_b64_tr_b16 v[40:41], v147 offset:16384
    s_add_u32 m0, s62, 49152
    v_mfma_f32_16x16x32_bf16 v[160:163], v[36:39], a[144:147], v[160:163]
    ds_read_b64_tr_b16 v[42:43], v147 offset:17408
    buffer_load_dwordx4 v6, s[24:27], s64 offen offset:0 lds
    v_mfma_f32_16x16x32_bf16 v[168:171], v[36:39], a[148:151], v[168:171]
    ds_read_b64_tr_b16 v[44:45], v147 offset:24576
    s_xor_b32 s80, s51, 7
    v_mfma_f32_16x16x32_bf16 v[168:171], v[32:35], a[132:135], v[168:171]
    ds_read_b64_tr_b16 v[46:47], v147 offset:25600
    buffer_load_dwordx4 v7, s[24:27], s64 offen offset:1024 lds
    s_waitcnt lgkmcnt(6)
    v_mfma_f32_16x16x32_bf16 v[176:179], v[32:35], a[136:139], v[176:179]
    ds_read_b64_tr_b16 v[48:49], v148 offset:16384
    s_lshl_b32 s63, s80, 7
    v_mfma_f32_16x16x32_bf16 v[176:179], v[36:39], a[152:155], v[176:179]
    ds_read_b64_tr_b16 v[50:51], v148 offset:17408
    s_add_u32 s63, s63, s53
    s_waitcnt lgkmcnt(6)
    v_mfma_f32_16x16x32_bf16 v[184:187], v[36:39], a[156:159], v[184:187]
    ds_read_b64_tr_b16 v[52:53], v148 offset:24576
    v_mfma_f32_16x16x32_bf16 v[184:187], v[32:35], a[140:143], v[184:187]
    ds_read_b64_tr_b16 v[54:55], v148 offset:25600
    buffer_load_dwordx4 v8, s[24:27], s64 offen offset:2048 lds
    s_waitcnt lgkmcnt(4)
    v_mfma_f32_16x16x32_bf16 v[188:191], v[40:43], a[140:143], v[188:191]
    ds_read_b64_tr_b16 v[56:57], v149 offset:16384
    v_mfma_f32_16x16x32_bf16 v[188:191], v[44:47], a[156:159], v[188:191]
    ds_read_b64_tr_b16 v[58:59], v149 offset:17408
    buffer_load_dwordx4 v9, s[24:27], s64 offen offset:3072 lds
    v_mfma_f32_16x16x32_bf16 v[180:183], v[44:47], a[152:155], v[180:183]
    ds_read_b64_tr_b16 v[60:61], v149 offset:24576
    s_add_u32 m0, s60, 147456
    v_mfma_f32_16x16x32_bf16 v[180:183], v[40:43], a[136:139], v[180:183]
    ds_read_b64_tr_b16 v[62:63], v149 offset:25600
    buffer_load_dwordx4 v10, s[44:47], s14 offen lds
    v_mfma_f32_16x16x32_bf16 v[172:175], v[40:43], a[132:135], v[172:175]
    v_mfma_f32_16x16x32_bf16 v[172:175], v[44:47], a[148:151], v[172:175]
    v_mfma_f32_16x16x32_bf16 v[164:167], v[44:47], a[144:147], v[164:167]
    s_add_u32 m0, s60, 148480
    v_mfma_f32_16x16x32_bf16 v[164:167], v[40:43], a[128:131], v[164:167]
    buffer_load_dwordx4 v11, s[44:47], s14 offen lds
    s_waitcnt vmcnt(10) lgkmcnt(0)
    s_barrier
    v_mfma_f32_16x16x32_bf16 v[192:195], v[48:51], a[128:131], v[192:195]
    ds_read_b128 a[160:163], v144 offset:32768
    s_add_u32 m0, s62, 16384
    v_mfma_f32_16x16x32_bf16 v[192:195], v[52:55], a[144:147], v[192:195]
    ds_read_b64_tr_b16 v[32:33], v146 offset:32768
    buffer_load_dwordx4 v2, s[20:23], s63 offen offset:0 lds
    v_mfma_f32_16x16x32_bf16 v[200:203], v[52:55], a[148:151], v[200:203]
    ds_read_b128 a[176:179], v145 offset:32768
    s_mul_i32 s64, s80, s89
    v_mfma_f32_16x16x32_bf16 v[200:203], v[48:51], a[132:135], v[200:203]
    ds_read_b64_tr_b16 v[34:35], v146 offset:33792
    s_add_u32 s64, s64, s54
    v_mfma_f32_16x16x32_bf16 v[208:211], v[48:51], a[136:139], v[208:211]
    ds_read_b128 a[164:167], v144 offset:34816
    s_mul_i32 s14, s80, s4
    v_mfma_f32_16x16x32_bf16 v[208:211], v[52:55], a[152:155], v[208:211]
    ds_read_b64_tr_b16 v[36:37], v146 offset:40960
    buffer_load_dwordx4 v3, s[20:23], s63 offen offset:1024 lds
    v_mfma_f32_16x16x32_bf16 v[216:219], v[52:55], a[156:159], v[216:219]
    ds_read_b128 a[180:183], v145 offset:34816
    s_add_u32 s14, s14, s61
    v_mfma_f32_16x16x32_bf16 v[216:219], v[48:51], a[140:143], v[216:219]
    ds_read_b64_tr_b16 v[38:39], v146 offset:41984
    v_mfma_f32_16x16x32_bf16 v[220:223], v[56:59], a[140:143], v[220:223]
    ds_read_b128 a[168:171], v144 offset:36864
    v_mfma_f32_16x16x32_bf16 v[220:223], v[60:63], a[156:159], v[220:223]
    buffer_load_dwordx4 v4, s[20:23], s63 offen offset:2048 lds
    v_mul_u32_u24 v74, 86, v73
    v_lshrrev_b32 v74, 8, v74
    v_lshlrev_b32 v74, 10, v74
    s_bfe_u32 s77, s2, 262147
    s_mul_i32 s76, s77, 88064
    buffer_load_dword v27, v74, s[28:31], s76 offen offset:384
    v_lshrrev_b32 v74, 3, v73
    v_lshlrev_b32 v74, 10, v74
    s_lshl_b32 s76, s77, 15
    buffer_load_dword v27, v74, s[32:35], s76 offen offset:384
    v_mfma_f32_16x16x32_bf16 v[212:215], v[60:63], a[152:155], v[212:215]
    ds_read_b128 a[184:187], v145 offset:36864
    v_mfma_f32_16x16x32_bf16 v[212:215], v[56:59], a[136:139], v[212:215]
    v_mfma_f32_16x16x32_bf16 v[204:207], v[56:59], a[132:135], v[204:207]
    ds_read_b128 a[172:175], v144 offset:38912
    v_mfma_f32_16x16x32_bf16 v[204:207], v[60:63], a[148:151], v[204:207]
    buffer_load_dwordx4 v5, s[20:23], s63 offen offset:3072 lds
    v_mfma_f32_16x16x32_bf16 v[196:199], v[60:63], a[144:147], v[196:199]
    ds_read_b128 a[188:191], v145 offset:38912
    v_mfma_f32_16x16x32_bf16 v[196:199], v[56:59], a[128:131], v[196:199]
    s_waitcnt lgkmcnt(4)
    v_mfma_f32_16x16x32_bf16 v[160:163], v[32:35], a[160:163], v[160:163]
    ds_read_b64_tr_b16 v[40:41], v147 offset:32768
    s_add_u32 m0, s62, 65536
    v_mfma_f32_16x16x32_bf16 v[160:163], v[36:39], a[176:179], v[160:163]
    ds_read_b64_tr_b16 v[42:43], v147 offset:33792
    buffer_load_dwordx4 v6, s[24:27], s64 offen offset:0 lds
    v_mfma_f32_16x16x32_bf16 v[168:171], v[36:39], a[180:183], v[168:171]
    ds_read_b64_tr_b16 v[44:45], v147 offset:40960
    s_add_u32 s63, s71, 0
    v_mfma_f32_16x16x32_bf16 v[168:171], v[32:35], a[164:167], v[168:171]
    ds_read_b64_tr_b16 v[46:47], v147 offset:41984
    buffer_load_dwordx4 v7, s[24:27], s64 offen offset:1024 lds
    s_waitcnt lgkmcnt(6)
    v_mfma_f32_16x16x32_bf16 v[176:179], v[32:35], a[168:171], v[176:179]
    ds_read_b64_tr_b16 v[48:49], v148 offset:32768
    v_mfma_f32_16x16x32_bf16 v[176:179], v[36:39], a[184:187], v[176:179]
    ds_read_b64_tr_b16 v[50:51], v148 offset:33792
    s_waitcnt lgkmcnt(6)
    v_mfma_f32_16x16x32_bf16 v[184:187], v[36:39], a[188:191], v[184:187]
    ds_read_b64_tr_b16 v[52:53], v148 offset:40960
    v_mfma_f32_16x16x32_bf16 v[184:187], v[32:35], a[172:175], v[184:187]
    ds_read_b64_tr_b16 v[54:55], v148 offset:41984
    buffer_load_dwordx4 v8, s[24:27], s64 offen offset:2048 lds
    s_waitcnt lgkmcnt(4)
    v_mfma_f32_16x16x32_bf16 v[188:191], v[40:43], a[172:175], v[188:191]
    ds_read_b64_tr_b16 v[56:57], v149 offset:32768
    v_mfma_f32_16x16x32_bf16 v[188:191], v[44:47], a[188:191], v[188:191]
    ds_read_b64_tr_b16 v[58:59], v149 offset:33792
    buffer_load_dwordx4 v9, s[24:27], s64 offen offset:3072 lds
    v_mfma_f32_16x16x32_bf16 v[180:183], v[44:47], a[184:187], v[180:183]
    ds_read_b64_tr_b16 v[60:61], v149 offset:40960
    s_add_u32 m0, s60, 155648
    v_mfma_f32_16x16x32_bf16 v[180:183], v[40:43], a[168:171], v[180:183]
    ds_read_b64_tr_b16 v[62:63], v149 offset:41984
    buffer_load_dwordx4 v10, s[44:47], s14 offen lds
    v_mfma_f32_16x16x32_bf16 v[172:175], v[40:43], a[164:167], v[172:175]
    v_mfma_f32_16x16x32_bf16 v[172:175], v[44:47], a[180:183], v[172:175]
    v_mfma_f32_16x16x32_bf16 v[164:167], v[44:47], a[176:179], v[164:167]
    s_add_u32 m0, s60, 156672
    v_mfma_f32_16x16x32_bf16 v[164:167], v[40:43], a[160:163], v[164:167]
    buffer_load_dwordx4 v11, s[44:47], s14 offen lds
    s_waitcnt vmcnt(12) lgkmcnt(0)
    s_barrier
    v_mfma_f32_16x16x32_bf16 v[192:195], v[48:51], a[160:163], v[192:195]
    ds_read_b128 a[192:195], v144 offset:0
    s_add_u32 m0, s12, 32768
    v_mfma_f32_16x16x32_bf16 v[192:195], v[52:55], a[176:179], v[192:195]
    ds_read_b64_tr_b16 v[32:33], v146 offset:0
    buffer_load_dwordx4 v12, s[28:31], s63 offen offset:0 lds
    v_mfma_f32_16x16x32_bf16 v[200:203], v[52:55], a[180:183], v[200:203]
    ds_read_b128 a[208:211], v145 offset:0
    s_add_u32 s64, s71, 196608
    v_mfma_f32_16x16x32_bf16 v[200:203], v[48:51], a[164:167], v[200:203]
    ds_read_b64_tr_b16 v[34:35], v146 offset:1024
    v_mfma_f32_16x16x32_bf16 v[208:211], v[48:51], a[168:171], v[208:211]
    ds_read_b128 a[196:199], v144 offset:2048
    v_mfma_f32_16x16x32_bf16 v[208:211], v[52:55], a[184:187], v[208:211]
    ds_read_b64_tr_b16 v[36:37], v146 offset:8192
    buffer_load_dwordx4 v13, s[28:31], s63 offen offset:1024 lds
    v_mfma_f32_16x16x32_bf16 v[216:219], v[52:55], a[188:191], v[216:219]
    ds_read_b128 a[212:215], v145 offset:2048
    v_mfma_f32_16x16x32_bf16 v[216:219], v[48:51], a[172:175], v[216:219]
    ds_read_b64_tr_b16 v[38:39], v146 offset:9216
    v_mfma_f32_16x16x32_bf16 v[220:223], v[56:59], a[172:175], v[220:223]
    ds_read_b128 a[200:203], v144 offset:4096
    v_mfma_f32_16x16x32_bf16 v[220:223], v[60:63], a[188:191], v[220:223]
    buffer_load_dwordx4 v14, s[28:31], s63 offen offset:2048 lds
    v_mfma_f32_16x16x32_bf16 v[212:215], v[60:63], a[184:187], v[212:215]
    ds_read_b128 a[216:219], v145 offset:4096
    v_mfma_f32_16x16x32_bf16 v[212:215], v[56:59], a[168:171], v[212:215]
    v_mfma_f32_16x16x32_bf16 v[204:207], v[56:59], a[164:167], v[204:207]
    ds_read_b128 a[204:207], v144 offset:6144
    v_mfma_f32_16x16x32_bf16 v[204:207], v[60:63], a[180:183], v[204:207]
    buffer_load_dwordx4 v15, s[28:31], s63 offen offset:3072 lds
    v_mfma_f32_16x16x32_bf16 v[196:199], v[60:63], a[176:179], v[196:199]
    ds_read_b128 a[220:223], v145 offset:6144
    v_mfma_f32_16x16x32_bf16 v[196:199], v[56:59], a[160:163], v[196:199]
    s_waitcnt lgkmcnt(4)
    v_mfma_f32_16x16x32_bf16 v[160:163], v[32:35], a[192:195], v[160:163]
    ds_read_b64_tr_b16 v[40:41], v147 offset:0
    s_add_u32 m0, s12, 81920
    v_mfma_f32_16x16x32_bf16 v[160:163], v[36:39], a[208:211], v[160:163]
    ds_read_b64_tr_b16 v[42:43], v147 offset:1024
    buffer_load_dwordx4 v12, s[28:31], s64 offen offset:0 lds
    v_mfma_f32_16x16x32_bf16 v[168:171], v[36:39], a[212:215], v[168:171]
    ds_read_b64_tr_b16 v[44:45], v147 offset:8192
    s_add_u32 s63, s71, 360448
    v_mfma_f32_16x16x32_bf16 v[168:171], v[32:35], a[196:199], v[168:171]
    ds_read_b64_tr_b16 v[46:47], v147 offset:9216
    s_waitcnt lgkmcnt(6)
    v_mfma_f32_16x16x32_bf16 v[176:179], v[32:35], a[200:203], v[176:179]
    ds_read_b64_tr_b16 v[48:49], v148 offset:0
    v_mfma_f32_16x16x32_bf16 v[176:179], v[36:39], a[216:219], v[176:179]
    ds_read_b64_tr_b16 v[50:51], v148 offset:1024
    buffer_load_dwordx4 v13, s[28:31], s64 offen offset:1024 lds
    s_waitcnt lgkmcnt(6)
    v_mfma_f32_16x16x32_bf16 v[184:187], v[36:39], a[220:223], v[184:187]
    ds_read_b64_tr_b16 v[52:53], v148 offset:8192
    v_mfma_f32_16x16x32_bf16 v[184:187], v[32:35], a[204:207], v[184:187]
    ds_read_b64_tr_b16 v[54:55], v148 offset:9216
    s_waitcnt lgkmcnt(4)
    v_mfma_f32_16x16x32_bf16 v[188:191], v[40:43], a[204:207], v[188:191]
    ds_read_b64_tr_b16 v[56:57], v149 offset:0
    v_mfma_f32_16x16x32_bf16 v[188:191], v[44:47], a[220:223], v[188:191]
    ds_read_b64_tr_b16 v[58:59], v149 offset:1024
    buffer_load_dwordx4 v14, s[28:31], s64 offen offset:2048 lds
    v_add_u32 v2, 0x10000, v16
    v_add_u32 v3, 0x10000, v17
    v_add_u32 v4, 0x10000, v18
    v_add_u32 v5, 0x10000, v19
    v_mfma_f32_16x16x32_bf16 v[180:183], v[44:47], a[216:219], v[180:183]
    ds_read_b64_tr_b16 v[60:61], v149 offset:8192
    v_mfma_f32_16x16x32_bf16 v[180:183], v[40:43], a[200:203], v[180:183]
    ds_read_b64_tr_b16 v[62:63], v149 offset:9216
    v_mfma_f32_16x16x32_bf16 v[172:175], v[40:43], a[196:199], v[172:175]
    v_mfma_f32_16x16x32_bf16 v[172:175], v[44:47], a[212:215], v[172:175]
    buffer_load_dwordx4 v15, s[28:31], s64 offen offset:3072 lds
    v_mfma_f32_16x16x32_bf16 v[164:167], v[44:47], a[208:211], v[164:167]
    v_mfma_f32_16x16x32_bf16 v[164:167], v[40:43], a[192:195], v[164:167]
    s_waitcnt vmcnt(8) lgkmcnt(0)
    s_barrier
    v_mfma_f32_16x16x32_bf16 v[192:195], v[48:51], a[192:195], v[192:195]
    ds_read_b128 a[224:227], v144 offset:16384
    s_add_u32 m0, s12, 0
    v_mfma_f32_16x16x32_bf16 v[192:195], v[52:55], a[208:211], v[192:195]
    ds_read_b64_tr_b16 v[32:33], v146 offset:16384
    buffer_load_dwordx4 v12, s[28:31], s63 offen offset:0 lds
    v_mfma_f32_16x16x32_bf16 v[200:203], v[52:55], a[212:215], v[200:203]
    ds_read_b128 a[240:243], v145 offset:16384
    s_add_u32 s64, s71, 557056
    v_mfma_f32_16x16x32_bf16 v[200:203], v[48:51], a[196:199], v[200:203]
    ds_read_b64_tr_b16 v[34:35], v146 offset:17408
    v_mfma_f32_16x16x32_bf16 v[208:211], v[48:51], a[200:203], v[208:211]
    ds_read_b128 a[228:231], v144 offset:18432
    v_mfma_f32_16x16x32_bf16 v[208:211], v[52:55], a[216:219], v[208:211]
    ds_read_b64_tr_b16 v[36:37], v146 offset:24576
    buffer_load_dwordx4 v13, s[28:31], s63 offen offset:1024 lds
    v_mfma_f32_16x16x32_bf16 v[216:219], v[52:55], a[220:223], v[216:219]
    ds_read_b128 a[244:247], v145 offset:18432
    v_mfma_f32_16x16x32_bf16 v[216:219], v[48:51], a[204:207], v[216:219]
    ds_read_b64_tr_b16 v[38:39], v146 offset:25600
    v_mfma_f32_16x16x32_bf16 v[220:223], v[56:59], a[204:207], v[220:223]
    ds_read_b128 a[232:235], v144 offset:20480
    v_mfma_f32_16x16x32_bf16 v[220:223], v[60:63], a[220:223], v[220:223]
    buffer_load_dwordx4 v14, s[28:31], s63 offen offset:2048 lds
    v_mfma_f32_16x16x32_bf16 v[212:215], v[60:63], a[216:219], v[212:215]
    ds_read_b128 a[248:251], v145 offset:20480
    v_mfma_f32_16x16x32_bf16 v[212:215], v[56:59], a[200:203], v[212:215]
    v_mfma_f32_16x16x32_bf16 v[204:207], v[56:59], a[196:199], v[204:207]
    ds_read_b128 a[236:239], v144 offset:22528
    v_mfma_f32_16x16x32_bf16 v[204:207], v[60:63], a[212:215], v[204:207]
    buffer_load_dwordx4 v15, s[28:31], s63 offen offset:3072 lds
    v_mfma_f32_16x16x32_bf16 v[196:199], v[60:63], a[208:211], v[196:199]
    ds_read_b128 a[252:255], v145 offset:22528
    v_mfma_f32_16x16x32_bf16 v[196:199], v[56:59], a[192:195], v[196:199]
    s_waitcnt lgkmcnt(4)
    v_mfma_f32_16x16x32_bf16 v[160:163], v[32:35], a[224:227], v[160:163]
    ds_read_b64_tr_b16 v[40:41], v147 offset:16384
    s_add_u32 m0, s12, 49152
    v_mfma_f32_16x16x32_bf16 v[160:163], v[36:39], a[240:243], v[160:163]
    ds_read_b64_tr_b16 v[42:43], v147 offset:17408
    buffer_load_dwordx4 v12, s[28:31], s64 offen offset:0 lds
    v_mfma_f32_16x16x32_bf16 v[168:171], v[36:39], a[244:247], v[168:171]
    ds_read_b64_tr_b16 v[44:45], v147 offset:24576
    v_mfma_f32_16x16x32_bf16 v[168:171], v[32:35], a[228:231], v[168:171]
    ds_read_b64_tr_b16 v[46:47], v147 offset:25600
    s_waitcnt lgkmcnt(6)
    v_mfma_f32_16x16x32_bf16 v[176:179], v[32:35], a[232:235], v[176:179]
    ds_read_b64_tr_b16 v[48:49], v148 offset:16384
    v_mfma_f32_16x16x32_bf16 v[176:179], v[36:39], a[248:251], v[176:179]
    ds_read_b64_tr_b16 v[50:51], v148 offset:17408
    buffer_load_dwordx4 v13, s[28:31], s64 offen offset:1024 lds
    s_waitcnt lgkmcnt(6)
    v_mfma_f32_16x16x32_bf16 v[184:187], v[36:39], a[252:255], v[184:187]
    ds_read_b64_tr_b16 v[52:53], v148 offset:24576
    v_mfma_f32_16x16x32_bf16 v[184:187], v[32:35], a[236:239], v[184:187]
    ds_read_b64_tr_b16 v[54:55], v148 offset:25600
    s_waitcnt lgkmcnt(4)
    v_mfma_f32_16x16x32_bf16 v[188:191], v[40:43], a[236:239], v[188:191]
    ds_read_b64_tr_b16 v[56:57], v149 offset:16384
    v_mfma_f32_16x16x32_bf16 v[188:191], v[44:47], a[252:255], v[188:191]
    ds_read_b64_tr_b16 v[58:59], v149 offset:17408
    buffer_load_dwordx4 v14, s[28:31], s64 offen offset:2048 lds
    v_mfma_f32_16x16x32_bf16 v[180:183], v[44:47], a[248:251], v[180:183]
    ds_read_b64_tr_b16 v[60:61], v149 offset:24576
    v_mfma_f32_16x16x32_bf16 v[180:183], v[40:43], a[232:235], v[180:183]
    ds_read_b64_tr_b16 v[62:63], v149 offset:25600
    v_mfma_f32_16x16x32_bf16 v[172:175], v[40:43], a[228:231], v[172:175]
    v_mfma_f32_16x16x32_bf16 v[172:175], v[44:47], a[244:247], v[172:175]
    buffer_load_dwordx4 v15, s[28:31], s64 offen offset:3072 lds
    v_mfma_f32_16x16x32_bf16 v[164:167], v[44:47], a[240:243], v[164:167]
    v_mfma_f32_16x16x32_bf16 v[164:167], v[40:43], a[224:227], v[164:167]
    s_waitcnt lgkmcnt(0)
    s_barrier
    v_mfma_f32_16x16x32_bf16 v[192:195], v[48:51], a[224:227], v[192:195]
    ds_read_b64_tr_b16 v[32:33], v150 offset:0
    v_mfma_f32_16x16x32_bf16 v[192:195], v[52:55], a[240:243], v[192:195]
    ds_read_b64_tr_b16 v[34:35], v150 offset:512
    v_mfma_f32_16x16x32_bf16 v[200:203], v[52:55], a[244:247], v[200:203]
    ds_read_b64_tr_b16 v[36:37], v150 offset:4096
    v_mfma_f32_16x16x32_bf16 v[200:203], v[48:51], a[228:231], v[200:203]
    ds_read_b64_tr_b16 v[38:39], v150 offset:4608
    v_mfma_f32_16x16x32_bf16 v[208:211], v[48:51], a[232:235], v[208:211]
    ds_read_b64_tr_b16 v[40:41], v151 offset:0
    v_mfma_f32_16x16x32_bf16 v[208:211], v[52:55], a[248:251], v[208:211]
    ds_read_b64_tr_b16 v[42:43], v151 offset:512
    v_mfma_f32_16x16x32_bf16 v[216:219], v[52:55], a[252:255], v[216:219]
    ds_read_b64_tr_b16 v[44:45], v151 offset:4096
    v_mfma_f32_16x16x32_bf16 v[216:219], v[48:51], a[236:239], v[216:219]
    ds_read_b64_tr_b16 v[46:47], v151 offset:4608
    v_mfma_f32_16x16x32_bf16 v[220:223], v[56:59], a[236:239], v[220:223]
    v_mfma_f32_16x16x32_bf16 v[220:223], v[60:63], a[252:255], v[220:223]
    v_mfma_f32_16x16x32_bf16 v[212:215], v[60:63], a[248:251], v[212:215]
    v_mfma_f32_16x16x32_bf16 v[212:215], v[56:59], a[232:235], v[212:215]
    v_mfma_f32_16x16x32_bf16 v[204:207], v[56:59], a[228:231], v[204:207]
    v_mfma_f32_16x16x32_bf16 v[204:207], v[60:63], a[244:247], v[204:207]
    v_mfma_f32_16x16x32_bf16 v[196:199], v[60:63], a[240:243], v[196:199]
    v_mfma_f32_16x16x32_bf16 v[196:199], v[56:59], a[224:227], v[196:199]
    s_waitcnt lgkmcnt(4)
    v_mfma_f32_16x16x32_bf16 v[224:227], v[32:35], a[0:3], 0
    ds_read_b64_tr_b16 v[48:49], v150 offset:8192
    v_mfma_f32_16x16x32_bf16 v[224:227], v[36:39], a[16:19], v[224:227]
    v_mfma_f32_16x16x32_bf16 v[232:235], v[36:39], a[20:23], 0
    ds_read_b64_tr_b16 v[50:51], v150 offset:8704
    v_mfma_f32_16x16x32_bf16 v[232:235], v[32:35], a[4:7], v[232:235]
    v_mfma_f32_16x16x32_bf16 v[240:243], v[32:35], a[8:11], 0
    ds_read_b64_tr_b16 v[52:53], v150 offset:12288
    v_cvt_pk_bf16_f32 v64, v160, v161
    v_mfma_f32_16x16x32_bf16 v[240:243], v[36:39], a[24:27], v[240:243]
    v_cvt_pk_bf16_f32 v65, v162, v163
    v_cvt_pk_bf16_f32 v66, v164, v165
    v_cvt_pk_bf16_f32 v67, v166, v167
    v_cvt_pk_bf16_f32 v68, v168, v169
    v_cvt_pk_bf16_f32 v69, v170, v171
    v_cvt_pk_bf16_f32 v70, v172, v173
    v_cvt_pk_bf16_f32 v71, v174, v175
    v_pk_max_i16 v64, v64, 0
    v_mfma_f32_16x16x32_bf16 v[248:251], v[36:39], a[28:31], 0
    ds_read_b64_tr_b16 v[54:55], v150 offset:12800
    v_pk_max_i16 v65, v65, 0
    v_mfma_f32_16x16x32_bf16 v[248:251], v[32:35], a[12:15], v[248:251]
    v_pk_max_i16 v66, v66, 0
    v_pk_max_i16 v67, v67, 0
    v_pk_max_i16 v68, v68, 0
    v_pk_max_i16 v69, v69, 0
    v_pk_max_i16 v70, v70, 0
    v_pk_max_i16 v71, v71, 0
    buffer_store_dwordx4 v[64:67], v23, s[36:39], s82 offen offset:0 sc1
    buffer_store_dwordx4 v[68:71], v23, s[36:39], s82 offen offset:1536 sc1
    s_waitcnt lgkmcnt(4)
    v_mfma_f32_16x16x32_bf16 v[252:255], v[40:43], a[12:15], 0
    ds_read_b64_tr_b16 v[56:57], v151 offset:8192
    v_cvt_pk_bf16_f32 v72, v176, v177
    v_mfma_f32_16x16x32_bf16 v[252:255], v[44:47], a[28:31], v[252:255]
    v_cvt_pk_bf16_f32 v73, v178, v179
    v_cvt_pk_bf16_f32 v74, v180, v181
    v_cvt_pk_bf16_f32 v75, v182, v183
    v_cvt_pk_bf16_f32 v76, v184, v185
    v_cvt_pk_bf16_f32 v77, v186, v187
    v_cvt_pk_bf16_f32 v78, v188, v189
    v_cvt_pk_bf16_f32 v79, v190, v191
    v_pk_max_i16 v72, v72, 0
    v_pk_max_i16 v73, v73, 0
    v_mfma_f32_16x16x32_bf16 v[244:247], v[44:47], a[24:27], 0
    ds_read_b64_tr_b16 v[58:59], v151 offset:8704
    v_pk_max_i16 v74, v74, 0
    v_mfma_f32_16x16x32_bf16 v[244:247], v[40:43], a[8:11], v[244:247]
    v_pk_max_i16 v75, v75, 0
    v_pk_max_i16 v76, v76, 0
    v_pk_max_i16 v77, v77, 0
    v_pk_max_i16 v78, v78, 0
    v_pk_max_i16 v79, v79, 0
    s_add_u32 s82, s82, 181248
    buffer_store_dwordx4 v[72:75], v23, s[36:39], s82 offen offset:0 sc1
    buffer_store_dwordx4 v[76:79], v23, s[36:39], s82 offen offset:1536 sc1
    v_mfma_f32_16x16x32_bf16 v[236:239], v[40:43], a[4:7], 0
    ds_read_b64_tr_b16 v[60:61], v151 offset:12288
    v_cvt_pk_bf16_f32 v80, v192, v193
    v_mfma_f32_16x16x32_bf16 v[236:239], v[44:47], a[20:23], v[236:239]
    v_cvt_pk_bf16_f32 v81, v194, v195
    v_cvt_pk_bf16_f32 v82, v196, v197
    v_cvt_pk_bf16_f32 v83, v198, v199
    v_cvt_pk_bf16_f32 v84, v200, v201
    v_cvt_pk_bf16_f32 v85, v202, v203
    v_cvt_pk_bf16_f32 v86, v204, v205
    v_cvt_pk_bf16_f32 v87, v206, v207
    v_pk_max_i16 v80, v80, 0
    v_mfma_f32_16x16x32_bf16 v[228:231], v[44:47], a[16:19], 0
    ds_read_b64_tr_b16 v[62:63], v151 offset:12800
    v_pk_max_i16 v81, v81, 0
    v_mfma_f32_16x16x32_bf16 v[228:231], v[40:43], a[0:3], v[228:231]
    v_pk_max_i16 v82, v82, 0
    v_pk_max_i16 v83, v83, 0
    v_pk_max_i16 v84, v84, 0
    v_pk_max_i16 v85, v85, 0
    v_pk_max_i16 v86, v86, 0
    v_pk_max_i16 v87, v87, 0
    buffer_store_dwordx4 v[80:83], v23, s[36:39], s83 offen offset:0 sc1
    buffer_store_dwordx4 v[84:87], v23, s[36:39], s83 offen offset:1536 sc1
    s_waitcnt lgkmcnt(4)
    v_mfma_f32_16x16x32_bf16 v[224:227], v[48:51], a[32:35], v[224:227]
    ds_read_b64_tr_b16 v[32:33], v150 offset:16384
    v_cvt_pk_bf16_f32 v88, v208, v209
    v_mfma_f32_16x16x32_bf16 v[224:227], v[52:55], a[48:51], v[224:227]
    v_cvt_pk_bf16_f32 v89, v210, v211
    v_cvt_pk_bf16_f32 v90, v212, v213
    v_cvt_pk_bf16_f32 v91, v214, v215
    v_cvt_pk_bf16_f32 v92, v216, v217
    v_cvt_pk_bf16_f32 v93, v218, v219
    v_cvt_pk_bf16_f32 v94, v220, v221
    v_cvt_pk_bf16_f32 v95, v222, v223
    v_pk_max_i16 v88, v88, 0
    v_pk_max_i16 v89, v89, 0
    v_mfma_f32_16x16x32_bf16 v[232:235], v[52:55], a[52:55], v[232:235]
    ds_read_b64_tr_b16 v[34:35], v150 offset:16896
    v_pk_max_i16 v90, v90, 0
    v_mfma_f32_16x16x32_bf16 v[232:235], v[48:51], a[36:39], v[232:235]
    v_pk_max_i16 v91, v91, 0
    v_pk_max_i16 v92, v92, 0
    v_pk_max_i16 v93, v93, 0
    v_pk_max_i16 v94, v94, 0
    v_pk_max_i16 v95, v95, 0
    s_add_u32 s83, s83, 181248
    buffer_store_dwordx4 v[88:91], v23, s[36:39], s83 offen offset:0 sc1
    buffer_store_dwordx4 v[92:95], v23, s[36:39], s83 offen offset:1536 sc1
    v_mfma_f32_16x16x32_bf16 v[240:243], v[48:51], a[40:43], v[240:243]
    ds_read_b64_tr_b16 v[36:37], v150 offset:20480
    s_add_u32 m0, s12, 16384
    v_mfma_f32_16x16x32_bf16 v[240:243], v[52:55], a[56:59], v[240:243]
    s_add_u32 s64, s71, 720896
    buffer_load_dwordx4 v12, s[28:31], s64 offen offset:0 lds
    v_mfma_f32_16x16x32_bf16 v[248:251], v[52:55], a[60:63], v[248:251]
    ds_read_b64_tr_b16 v[38:39], v150 offset:20992
    s_lshl2_add_u32 s88, s55, s3
    v_mfma_f32_16x16x32_bf16 v[248:251], v[48:51], a[44:47], v[248:251]
    buffer_load_dwordx4 v13, s[28:31], s64 offen offset:1024 lds
    s_waitcnt lgkmcnt(4)
    v_mfma_f32_16x16x32_bf16 v[252:255], v[56:59], a[44:47], v[252:255]
    ds_read_b64_tr_b16 v[40:41], v151 offset:16384
    v_mfma_f32_16x16x32_bf16 v[252:255], v[60:63], a[60:63], v[252:255]
    buffer_load_dwordx4 v14, s[28:31], s64 offen offset:2048 lds
    buffer_load_dwordx4 v15, s[28:31], s64 offen offset:3072 lds
    v_mfma_f32_16x16x32_bf16 v[244:247], v[60:63], a[56:59], v[244:247]
    ds_read_b64_tr_b16 v[42:43], v151 offset:16896
    s_lshl_b32 s88, s88, 7
    v_mfma_f32_16x16x32_bf16 v[244:247], v[56:59], a[40:43], v[244:247]
    s_add_u32 m0, s12, 65536
    s_add_u32 s64, s71, 917504
    buffer_load_dwordx4 v12, s[28:31], s64 offen offset:0 lds
    v_mfma_f32_16x16x32_bf16 v[236:239], v[56:59], a[36:39], v[236:239]
    ds_read_b64_tr_b16 v[44:45], v151 offset:20480
    v_mfma_f32_16x16x32_bf16 v[236:239], v[60:63], a[52:55], v[236:239]
    buffer_load_dwordx4 v13, s[28:31], s64 offen offset:1024 lds
    v_mfma_f32_16x16x32_bf16 v[228:231], v[60:63], a[48:51], v[228:231]
    ds_read_b64_tr_b16 v[46:47], v151 offset:20992
    v_mfma_f32_16x16x32_bf16 v[228:231], v[56:59], a[32:35], v[228:231]
    buffer_load_dwordx4 v14, s[28:31], s64 offen offset:2048 lds
    s_add_u32 s88, s88, 1835008
    s_waitcnt lgkmcnt(4)
    v_mfma_f32_16x16x32_bf16 v[224:227], v[32:35], a[64:67], v[224:227]
    ds_read_b64_tr_b16 v[48:49], v150 offset:24576
    v_mfma_f32_16x16x32_bf16 v[224:227], v[36:39], a[80:83], v[224:227]
    buffer_load_dwordx4 v15, s[28:31], s64 offen offset:3072 lds
    s_waitcnt vmcnt(28)
    ds_read_b64_tr_b16 a[0:1], v16 offset:32768
    v_mfma_f32_16x16x32_bf16 v[232:235], v[36:39], a[84:87], v[232:235]
    ds_read_b64_tr_b16 v[50:51], v150 offset:25088
    ds_read_b64_tr_b16 a[2:3], v16 offset:34816
    v_mfma_f32_16x16x32_bf16 v[232:235], v[32:35], a[68:71], v[232:235]
    v_mfma_f32_16x16x32_bf16 v[240:243], v[32:35], a[72:75], v[240:243]
    ds_read_b64_tr_b16 v[52:53], v150 offset:28672
    s_add_u32 s8, s88, 16384
    v_mfma_f32_16x16x32_bf16 v[240:243], v[36:39], a[88:91], v[240:243]
    ds_read_b64_tr_b16 a[4:5], v17 offset:32768
    v_mfma_f32_16x16x32_bf16 v[248:251], v[36:39], a[92:95], v[248:251]
    ds_read_b64_tr_b16 v[54:55], v150 offset:29184
    ds_read_b64_tr_b16 a[6:7], v17 offset:34816
    v_mfma_f32_16x16x32_bf16 v[248:251], v[32:35], a[76:79], v[248:251]
    s_waitcnt lgkmcnt(8)
    v_mfma_f32_16x16x32_bf16 v[252:255], v[40:43], a[76:79], v[252:255]
    ds_read_b64_tr_b16 v[56:57], v151 offset:24576
    ds_read_b64_tr_b16 a[8:9], v18 offset:32768
    v_mfma_f32_16x16x32_bf16 v[252:255], v[44:47], a[92:95], v[252:255]
    s_add_u32 s13, s88, 49152
    ds_read_b64_tr_b16 a[10:11], v18 offset:34816
    v_mfma_f32_16x16x32_bf16 v[244:247], v[44:47], a[88:91], v[244:247]
    ds_read_b64_tr_b16 v[58:59], v151 offset:25088
    ds_read_b64_tr_b16 a[12:13], v19 offset:32768
    v_mfma_f32_16x16x32_bf16 v[244:247], v[40:43], a[72:75], v[244:247]
    v_mfma_f32_16x16x32_bf16 v[236:239], v[40:43], a[68:71], v[236:239]
    ds_read_b64_tr_b16 v[60:61], v151 offset:28672
    ds_read_b64_tr_b16 a[14:15], v19 offset:34816
    v_mfma_f32_16x16x32_bf16 v[236:239], v[44:47], a[84:87], v[236:239]
    s_lshl1_add_u32 s77, s55, s57
    v_mfma_f32_16x16x32_bf16 v[228:231], v[44:47], a[80:83], v[228:231]
    ds_read_b64_tr_b16 v[62:63], v151 offset:29184
    v_mfma_f32_16x16x32_bf16 v[228:231], v[40:43], a[64:67], v[228:231]
    s_waitcnt lgkmcnt(1)
    s_add_u32 m0, s12, 32768
    s_add_u32 s64, s71, 1081344
    buffer_load_dwordx4 v12, s[28:31], s64 offen offset:0 lds
    v_mfma_f32_16x16x32_bf16 v[224:227], v[48:51], a[96:99], v[224:227]
    ds_read_b64_tr_b16 v[32:33], v150 offset:32768
    v_mfma_f32_16x16x32_bf16 v[224:227], v[52:55], a[112:115], v[224:227]
    buffer_load_dwordx4 v13, s[28:31], s64 offen offset:1024 lds
    s_xor_b32 s78, s77, 1
    buffer_load_dwordx4 v14, s[28:31], s64 offen offset:2048 lds
    v_mfma_f32_16x16x32_bf16 v[232:235], v[52:55], a[116:119], v[232:235]
    ds_read_b64_tr_b16 v[34:35], v150 offset:33280
    v_mfma_f32_16x16x32_bf16 v[232:235], v[48:51], a[100:103], v[232:235]
    buffer_load_dwordx4 v15, s[28:31], s64 offen offset:3072 lds
    s_waitcnt vmcnt(12)
    s_add_u32 s79, s69, 1835008
    s_mov_b64 exec, 15
    buffer_atomic_swap v1, v29, s[36:39], s79 offen sc1
    s_mov_b64 exec, -1
    ds_read_b64_tr_b16 a[16:17], v2 offset:16384
    v_mfma_f32_16x16x32_bf16 v[240:243], v[48:51], a[104:107], v[240:243]
    ds_read_b64_tr_b16 v[36:37], v150 offset:36864
    s_mul_i32 s67, s77, 181248
    v_mfma_f32_16x16x32_bf16 v[240:243], v[52:55], a[120:123], v[240:243]
    ds_read_b64_tr_b16 a[18:19], v2 offset:18432
    v_mfma_f32_16x16x32_bf16 v[248:251], v[52:55], a[124:127], v[248:251]
    ds_read_b64_tr_b16 v[38:39], v150 offset:37376
    ds_read_b64_tr_b16 a[20:21], v3 offset:16384
    v_mfma_f32_16x16x32_bf16 v[248:251], v[48:51], a[108:111], v[248:251]
    s_waitcnt lgkmcnt(7)
    v_mfma_f32_16x16x32_bf16 v[252:255], v[56:59], a[108:111], v[252:255]
    ds_read_b64_tr_b16 v[40:41], v151 offset:32768
    ds_read_b64_tr_b16 a[22:23], v3 offset:18432
    v_mfma_f32_16x16x32_bf16 v[252:255], v[60:63], a[124:127], v[252:255]
    s_mul_i32 s68, s78, 181248
    ds_read_b64_tr_b16 a[24:25], v4 offset:16384
    v_mfma_f32_16x16x32_bf16 v[244:247], v[60:63], a[120:123], v[244:247]
    ds_read_b64_tr_b16 v[42:43], v151 offset:33280
    ds_read_b64_tr_b16 a[26:27], v4 offset:18432
    v_mfma_f32_16x16x32_bf16 v[244:247], v[56:59], a[104:107], v[244:247]
    v_mfma_f32_16x16x32_bf16 v[236:239], v[56:59], a[100:103], v[236:239]
    ds_read_b64_tr_b16 v[44:45], v151 offset:36864
    ds_read_b64_tr_b16 a[28:29], v5 offset:16384
    v_mfma_f32_16x16x32_bf16 v[236:239], v[60:63], a[116:119], v[236:239]
    s_mul_i32 s76, s3, 3072
    v_mfma_f32_16x16x32_bf16 v[228:231], v[60:63], a[112:115], v[228:231]
    ds_read_b64_tr_b16 v[46:47], v151 offset:37376
    ds_read_b64_tr_b16 a[30:31], v5 offset:18432
    v_mfma_f32_16x16x32_bf16 v[228:231], v[56:59], a[96:99], v[228:231]
    s_waitcnt lgkmcnt(10)
    v_mfma_f32_16x16x32_bf16 v[224:227], v[32:35], a[128:131], v[224:227]
    ds_read_b64_tr_b16 v[48:49], v150 offset:40960
    v_mfma_f32_16x16x32_bf16 v[224:227], v[36:39], a[144:147], v[224:227]
    s_waitcnt lgkmcnt(1)
    s_add_u32 m0, s12, 81920
    s_add_u32 s64, s71, 1277952
    buffer_load_dwordx4 v12, s[28:31], s64 offen offset:0 lds
    buffer_load_dwordx4 v13, s[28:31], s64 offen offset:1024 lds
    v_mfma_f32_16x16x32_bf16 v[232:235], v[36:39], a[148:151], v[232:235]
    ds_read_b64_tr_b16 v[50:51], v150 offset:41472
    s_add_u32 s76, s76, 16777216
    v_mfma_f32_16x16x32_bf16 v[232:235], v[32:35], a[132:135], v[232:235]
    buffer_load_dwordx4 v14, s[28:31], s64 offen offset:2048 lds
    v_mfma_f32_16x16x32_bf16 v[240:243], v[32:35], a[136:139], v[240:243]
    ds_read_b64_tr_b16 v[52:53], v150 offset:45056
    v_mfma_f32_16x16x32_bf16 v[240:243], v[36:39], a[152:155], v[240:243]
    buffer_load_dwordx4 v15, s[28:31], s64 offen offset:3072 lds
    v_mfma_f32_16x16x32_bf16 v[248:251], v[36:39], a[156:159], v[248:251]
    ds_read_b64_tr_b16 v[54:55], v150 offset:45568
    ds_read_b64_tr_b16 a[32:33], v16 offset:0
    v_mfma_f32_16x16x32_bf16 v[248:251], v[32:35], a[140:143], v[248:251]
    s_add_u32 s67, s67, s76
    v_mfma_f32_16x16x32_bf16 v[252:255], v[40:43], a[140:143], v[252:255]
    ds_read_b64_tr_b16 v[56:57], v151 offset:40960
    ds_read_b64_tr_b16 a[34:35], v16 offset:2048
    v_mfma_f32_16x16x32_bf16 v[252:255], v[44:47], a[156:159], v[252:255]
    ds_read_b64_tr_b16 a[36:37], v17 offset:0
    v_mfma_f32_16x16x32_bf16 v[244:247], v[44:47], a[152:155], v[244:247]
    ds_read_b64_tr_b16 v[58:59], v151 offset:41472
    s_add_u32 s68, s68, s76
    v_mfma_f32_16x16x32_bf16 v[244:247], v[40:43], a[136:139], v[244:247]
    ds_read_b64_tr_b16 a[38:39], v17 offset:2048
    v_mfma_f32_16x16x32_bf16 v[236:239], v[40:43], a[132:135], v[236:239]
    ds_read_b64_tr_b16 v[60:61], v151 offset:45056
    ds_read_b64_tr_b16 a[40:41], v18 offset:0
    v_mfma_f32_16x16x32_bf16 v[236:239], v[44:47], a[148:151], v[236:239]
    v_mfma_f32_16x16x32_bf16 v[228:231], v[44:47], a[144:147], v[228:231]
    ds_read_b64_tr_b16 v[62:63], v151 offset:45568
    ds_read_b64_tr_b16 a[42:43], v18 offset:2048
    v_mfma_f32_16x16x32_bf16 v[228:231], v[40:43], a[128:131], v[228:231]
    s_lshl2_add_u32 s9, s55, s3
    s_waitcnt lgkmcnt(10)
    v_mfma_f32_16x16x32_bf16 v[224:227], v[48:51], a[160:163], v[224:227]
    ds_read_b64_tr_b16 v[32:33], v150 offset:49152
    ds_read_b64_tr_b16 a[44:45], v19 offset:0
    v_mfma_f32_16x16x32_bf16 v[224:227], v[52:55], a[176:179], v[224:227]
    ds_read_b64_tr_b16 a[46:47], v19 offset:2048
    v_mfma_f32_16x16x32_bf16 v[232:235], v[52:55], a[180:183], v[232:235]
    ds_read_b64_tr_b16 v[34:35], v150 offset:49664
    v_mfma_f32_16x16x32_bf16 v[232:235], v[48:51], a[164:167], v[232:235]
    s_waitcnt lgkmcnt(1)
    s_add_u32 m0, s12, 0
    s_add_u32 s64, s16, 131072
    buffer_load_dwordx4 v12, s[28:31], s64 offen offset:0 lds
    v_mfma_f32_16x16x32_bf16 v[240:243], v[48:51], a[168:171], v[240:243]
    ds_read_b64_tr_b16 v[36:37], v150 offset:53248
    s_lshl_b32 s9, s9, 7
    v_mfma_f32_16x16x32_bf16 v[240:243], v[52:55], a[184:187], v[240:243]
    buffer_load_dwordx4 v13, s[28:31], s64 offen offset:1024 lds
    v_mfma_f32_16x16x32_bf16 v[248:251], v[52:55], a[188:191], v[248:251]
    ds_read_b64_tr_b16 v[38:39], v150 offset:53760
    v_mfma_f32_16x16x32_bf16 v[248:251], v[48:51], a[172:175], v[248:251]
    buffer_load_dwordx4 v14, s[28:31], s64 offen offset:2048 lds
    v_mfma_f32_16x16x32_bf16 v[252:255], v[56:59], a[172:175], v[252:255]
    ds_read_b64_tr_b16 v[40:41], v151 offset:49152
    v_mfma_f32_16x16x32_bf16 v[252:255], v[60:63], a[188:191], v[252:255]
    buffer_load_dwordx4 v15, s[28:31], s64 offen offset:3072 lds
    s_add_u32 s9, s9, 16384
    ds_read_b64_tr_b16 a[48:49], v16 offset:49152
    v_mfma_f32_16x16x32_bf16 v[244:247], v[60:63], a[184:187], v[244:247]
    ds_read_b64_tr_b16 v[42:43], v151 offset:49664
    ds_read_b64_tr_b16 a[50:51], v16 offset:51200
    v_mfma_f32_16x16x32_bf16 v[244:247], v[56:59], a[168:171], v[244:247]
    v_mfma_f32_16x16x32_bf16 v[236:239], v[56:59], a[164:167], v[236:239]
    ds_read_b64_tr_b16 v[44:45], v151 offset:53248
    ds_read_b64_tr_b16 a[52:53], v17 offset:49152
    v_mfma_f32_16x16x32_bf16 v[236:239], v[60:63], a[180:183], v[236:239]
    s_mul_i32 s76, s58, 1536
    v_mfma_f32_16x16x32_bf16 v[228:231], v[60:63], a[176:179], v[228:231]
    ds_read_b64_tr_b16 v[46:47], v151 offset:53760
    ds_read_b64_tr_b16 a[54:55], v17 offset:51200
    v_mfma_f32_16x16x32_bf16 v[228:231], v[56:59], a[160:163], v[228:231]
    s_waitcnt lgkmcnt(8)
    v_mfma_f32_16x16x32_bf16 v[224:227], v[32:35], a[192:195], v[224:227]
    ds_read_b64_tr_b16 v[48:49], v150 offset:57344
    ds_read_b64_tr_b16 a[56:57], v18 offset:49152
    v_mfma_f32_16x16x32_bf16 v[224:227], v[36:39], a[208:211], v[224:227]
    v_mfma_f32_16x16x32_bf16 v[232:235], v[36:39], a[212:215], v[232:235]
    ds_read_b64_tr_b16 v[50:51], v150 offset:57856
    ds_read_b64_tr_b16 a[58:59], v18 offset:51200
    v_mfma_f32_16x16x32_bf16 v[232:235], v[32:35], a[196:199], v[232:235]
    s_sub_u32 s77, 1536, s76
    ds_read_b64_tr_b16 a[60:61], v19 offset:49152
    v_mfma_f32_16x16x32_bf16 v[240:243], v[32:35], a[200:203], v[240:243]
    ds_read_b64_tr_b16 v[52:53], v150 offset:61440
    ds_read_b64_tr_b16 a[62:63], v19 offset:51200
    v_mfma_f32_16x16x32_bf16 v[240:243], v[36:39], a[216:219], v[240:243]
    v_mfma_f32_16x16x32_bf16 v[248:251], v[36:39], a[220:223], v[248:251]
    ds_read_b64_tr_b16 v[54:55], v150 offset:61952
    v_add_u32 v6, s76, v23
    v_mfma_f32_16x16x32_bf16 v[248:251], v[32:35], a[204:207], v[248:251]
    s_waitcnt lgkmcnt(1)
    s_add_u32 m0, s12, 49152
    s_add_u32 s64, s16, 851968
    buffer_load_dwordx4 v12, s[28:31], s64 offen offset:0 lds
    v_mfma_f32_16x16x32_bf16 v[252:255], v[40:43], a[204:207], v[252:255]
    ds_read_b64_tr_b16 v[56:57], v151 offset:57344
    v_mfma_f32_16x16x32_bf16 v[252:255], v[44:47], a[220:223], v[252:255]
    buffer_load_dwordx4 v13, s[28:31], s64 offen offset:1024 lds
    v_mfma_f32_16x16x32_bf16 v[244:247], v[44:47], a[216:219], v[244:247]
    ds_read_b64_tr_b16 v[58:59], v151 offset:57856
    v_mfma_f32_16x16x32_bf16 v[244:247], v[40:43], a[200:203], v[244:247]
    buffer_load_dwordx4 v14, s[28:31], s64 offen offset:2048 lds
    v_add_u32 v7, s77, v23
    buffer_load_dwordx4 v15, s[28:31], s64 offen offset:3072 lds
    v_mfma_f32_16x16x32_bf16 v[236:239], v[40:43], a[196:199], v[236:239]
    ds_read_b64_tr_b16 v[60:61], v151 offset:61440
    v_mfma_f32_16x16x32_bf16 v[236:239], v[44:47], a[212:215], v[236:239]
    s_waitcnt vmcnt(21)
    ds_read_b64_tr_b16 a[64:65], v16 offset:16384
    v_mfma_f32_16x16x32_bf16 v[228:231], v[44:47], a[208:211], v[228:231]
    ds_read_b64_tr_b16 v[62:63], v151 offset:61952
    ds_read_b64_tr_b16 a[66:67], v16 offset:18432
    v_mfma_f32_16x16x32_bf16 v[228:231], v[40:43], a[192:195], v[228:231]
    s_lshl_b32 s76, s58, 3
    s_waitcnt lgkmcnt(6)
    v_mfma_f32_16x16x32_bf16 v[224:227], v[48:51], a[224:227], v[224:227]
    ds_read_b64_tr_b16 a[68:69], v17 offset:16384
    v_mfma_f32_16x16x32_bf16 v[224:227], v[52:55], a[240:243], v[224:227]
    v_mfma_f32_16x16x32_bf16 v[232:235], v[52:55], a[244:247], v[232:235]
    ds_read_b64_tr_b16 a[70:71], v17 offset:18432
    ds_read_b64_tr_b16 a[72:73], v18 offset:16384
    v_mfma_f32_16x16x32_bf16 v[232:235], v[48:51], a[228:231], v[232:235]
    v_mfma_f32_16x16x32_bf16 v[240:243], v[48:51], a[232:235], v[240:243]
    s_lshl_b32 s10, 0xff, s76
    ds_read_b64_tr_b16 a[74:75], v18 offset:18432
    v_mfma_f32_16x16x32_bf16 v[240:243], v[52:55], a[248:251], v[240:243]
    v_mfma_f32_16x16x32_bf16 v[248:251], v[52:55], a[252:255], v[248:251]
    ds_read_b64_tr_b16 a[76:77], v19 offset:16384
    v_mfma_f32_16x16x32_bf16 v[248:251], v[48:51], a[236:239], v[248:251]
    s_waitcnt lgkmcnt(6)
    v_mfma_f32_16x16x32_bf16 v[252:255], v[56:59], a[236:239], v[252:255]
    ds_read_b64_tr_b16 a[78:79], v19 offset:18432
    s_add_u32 s76, s76, s57
    v_mfma_f32_16x16x32_bf16 v[252:255], v[60:63], a[252:255], v[252:255]
    v_mfma_f32_16x16x32_bf16 v[244:247], v[60:63], a[248:251], v[244:247]
    v_mfma_f32_16x16x32_bf16 v[244:247], v[56:59], a[232:235], v[244:247]
    s_waitcnt lgkmcnt(0)
    s_add_u32 m0, s12, 16384
    s_add_u32 s64, s17, 327680
    buffer_load_dwordx4 v12, s[28:31], s64 offen offset:0 lds
    buffer_load_dwordx4 v13, s[28:31], s64 offen offset:1024 lds
    v_mfma_f32_16x16x32_bf16 v[236:239], v[56:59], a[228:231], v[236:239]
    v_mfma_f32_16x16x32_bf16 v[236:239], v[60:63], a[244:247], v[236:239]
    buffer_load_dwordx4 v14, s[28:31], s64 offen offset:2048 lds
    s_lshl_b32 s11, 0x55, s76
    v_mfma_f32_16x16x32_bf16 v[228:231], v[60:63], a[240:243], v[228:231]
    v_mfma_f32_16x16x32_bf16 v[228:231], v[56:59], a[224:227], v[228:231]
    buffer_load_dwordx4 v15, s[28:31], s64 offen offset:3072 lds
    s_barrier
    s_nop 5
    v_cvt_pk_bf16_f32 v96, v224, v225
    v_cvt_pk_bf16_f32 v97, v226, v227
    v_cvt_pk_bf16_f32 v98, v228, v229
    v_cvt_pk_bf16_f32 v99, v230, v231
    v_cvt_pk_bf16_f32 v100, v232, v233
    v_cvt_pk_bf16_f32 v101, v234, v235
    v_cvt_pk_bf16_f32 v102, v236, v237
    v_cvt_pk_bf16_f32 v103, v238, v239
    v_pk_max_i16 v96, v96, 0
    v_pk_max_i16 v97, v97, 0
    v_pk_max_i16 v98, v98, 0
    v_pk_max_i16 v99, v99, 0
    v_pk_max_i16 v100, v100, 0
    v_pk_max_i16 v101, v101, 0
    v_pk_max_i16 v102, v102, 0
    v_pk_max_i16 v103, v103, 0
    buffer_store_dwordx4 v[96:99], v23, s[36:39], s84 offen offset:0 sc1
    buffer_store_dwordx4 v[100:103], v23, s[36:39], s84 offen offset:1536 sc1
    s_cmp_eq_u32 s85, 1073741824
    s_cbranch_scc1 L_only1
    v_add_f32 v26, v224, v229
    v_add_f32 v27, v232, v237
    v_add_f32 v8, v240, v245
    v_add_f32 v9, v248, v253
    v_permlane16_swap_b32 v26, v27
    s_nop 0
    v_permlane16_swap_b32 v8, v9
    s_nop 1
    v_permlane32_swap_b32 v26, v8
    v_mul_f32 v26, s90, v26
    v_exp_f32_e64 v26, -v26
    s_nop 0
    v_add_f32 v26, 1.0, v26
    v_rcp_f32 v26, v26
    v_mov_b32 v27, s59
    v_lshlrev_b32 v8, 3, v0
    buffer_store_dwordx2 v[26:27], v8, s[36:39], s85 offen sc1
L_only1:
    v_cvt_pk_bf16_f32 v104, v240, v241
    v_cvt_pk_bf16_f32 v105, v242, v243
    v_cvt_pk_bf16_f32 v106, v244, v245
    v_cvt_pk_bf16_f32 v107, v246, v247
    v_cvt_pk_bf16_f32 v108, v248, v249
    v_cvt_pk_bf16_f32 v109, v250, v251
    v_cvt_pk_bf16_f32 v110, v252, v253
    v_cvt_pk_bf16_f32 v111, v254, v255
    v_pk_max_i16 v104, v104, 0
    v_pk_max_i16 v105, v105, 0
    v_pk_max_i16 v106, v106, 0
    v_pk_max_i16 v107, v107, 0
    v_pk_max_i16 v108, v108, 0
    v_pk_max_i16 v109, v109, 0
    v_pk_max_i16 v110, v110, 0
    v_pk_max_i16 v111, v111, 0
    s_add_u32 s84, s84, 181248
    buffer_store_dwordx4 v[104:107], v23, s[36:39], s84 offen offset:0 sc1
    buffer_store_dwordx4 v[108:111], v23, s[36:39], s84 offen offset:1536 sc1
    s_waitcnt vmcnt(25)
    ds_read_b64_tr_b16 a[80:81], v2 offset:0
    ds_read_b64_tr_b16 a[82:83], v2 offset:2048
    ds_read_b64_tr_b16 a[84:85], v3 offset:0
    ds_read_b64_tr_b16 a[86:87], v3 offset:2048
    ds_read_b64_tr_b16 a[88:89], v4 offset:0
    ds_read_b64_tr_b16 a[90:91], v4 offset:2048
    ds_read_b64_tr_b16 a[92:93], v5 offset:0
    ds_read_b64_tr_b16 a[94:95], v5 offset:2048
    s_waitcnt vmcnt(21)
    ds_read_b64_tr_b16 a[96:97], v16 offset:32768
    ds_read_b64_tr_b16 a[98:99], v16 offset:34816
    ds_read_b64_tr_b16 a[100:101], v17 offset:32768
    ds_read_b64_tr_b16 a[102:103], v17 offset:34816
    v_mov_b32 v28, 0
    s_mov_b64 exec, 0xffff
    buffer_atomic_or v28, v25, s[36:39], s88 offen offset:0 sc0 sc1
    s_mov_b64 exec, -1
    ds_read_b64_tr_b16 a[104:105], v18 offset:32768
    ds_read_b64_tr_b16 a[106:107], v18 offset:34816
    ds_read_b64_tr_b16 a[108:109], v19 offset:32768
    ds_read_b64_tr_b16 a[110:111], v19 offset:34816
    s_waitcnt lgkmcnt(8)
    s_add_u32 m0, s12, 65536
    s_add_u32 s64, s71, 0
    buffer_load_dwordx4 v12, s[32:35], s64 offen offset:0 lds
    s_waitcnt vmcnt(18)
    ds_read_b64_tr_b16 a[112:113], v2 offset:16384
    ds_read_b64_tr_b16 a[114:115], v2 offset:18432
    ds_read_b64_tr_b16 a[116:117], v3 offset:16384
    ds_read_b64_tr_b16 a[118:119], v3 offset:18432
    buffer_load_dwordx4 v13, s[32:35], s64 offen offset:1024 lds
    ds_read_b64_tr_b16 a[120:121], v4 offset:16384
    ds_read_b64_tr_b16 a[122:123], v4 offset:18432
    ds_read_b64_tr_b16 a[124:125], v5 offset:16384
    ds_read_b64_tr_b16 a[126:127], v5 offset:18432
    buffer_load_dwordx4 v14, s[32:35], s64 offen offset:2048 lds
    s_waitcnt vmcnt(16)
    ds_read_b64_tr_b16 a[128:129], v16 offset:0
    ds_read_b64_tr_b16 a[130:131], v16 offset:2048
    ds_read_b64_tr_b16 a[132:133], v17 offset:0
    ds_read_b64_tr_b16 a[134:135], v17 offset:2048
    buffer_load_dwordx4 v15, s[32:35], s64 offen offset:3072 lds
    s_waitcnt vmcnt(5)
    s_add_u32 s79, s69, 1884160
    s_mov_b64 exec, 15
    buffer_atomic_swap v1, v29, s[36:39], s79 offen sc1
    s_mov_b64 exec, -1
    ds_read_b64_tr_b16 a[136:137], v18 offset:0
    ds_read_b64_tr_b16 a[138:139], v18 offset:2048
    ds_read_b64_tr_b16 a[140:141], v19 offset:0
    ds_read_b64_tr_b16 a[142:143], v19 offset:2048
    s_waitcnt vmcnt(5)
    s_mov_b32 s70, 0
L_f1f_chk:
    v_cmp_ne_u32 vcc, s59, v28
    s_and_b32 s74, vcc_lo, s10
    s_cbranch_scc1 L_f1f_retry
L_f1f_ok:
    s_add_u32 s80, s67, 0
    buffer_load_dwordx4 v[32:35], v6, s[36:39], s80 offen sc1
    ds_read_b64_tr_b16 a[144:145], v16 offset:49152
    ds_read_b64_tr_b16 a[146:147], v16 offset:51200
    ds_read_b64_tr_b16 a[148:149], v17 offset:49152
    ds_read_b64_tr_b16 a[150:151], v17 offset:51200
    s_add_u32 s81, s67, 12288
    buffer_load_dwordx4 v[36:39], v6, s[36:39], s81 offen sc1
    ds_read_b64_tr_b16 a[152:153], v18 offset:49152
    ds_read_b64_tr_b16 a[154:155], v18 offset:51200
    ds_read_b64_tr_b16 a[156:157], v19 offset:49152
    ds_read_b64_tr_b16 a[158:159], v19 offset:51200
    s_waitcnt lgkmcnt(15)
    s_add_u32 m0, s12, 32768
    s_add_u32 s64, s71, 131072
    buffer_load_dwordx4 v12, s[32:35], s64 offen offset:0 lds
    ds_read_b64_tr_b16 a[160:161], v16 offset:16384
    ds_read_b64_tr_b16 a[162:163], v16 offset:18432
    ds_read_b64_tr_b16 a[164:165], v17 offset:16384
    ds_read_b64_tr_b16 a[166:167], v17 offset:18432
    buffer_load_dwordx4 v[40:43], v7, s[36:39], s80 offen sc1
    ds_read_b64_tr_b16 a[168:169], v18 offset:16384
    ds_read_b64_tr_b16 a[170:171], v18 offset:18432
    ds_read_b64_tr_b16 a[172:173], v19 offset:16384
    ds_read_b64_tr_b16 a[174:175], v19 offset:18432
    buffer_load_dwordx4 v[44:47], v7, s[36:39], s81 offen sc1
    buffer_load_dwordx4 v13, s[32:35], s64 offen offset:1024 lds
    s_add_u32 s80, s68, 0
    buffer_load_dwordx4 v[48:51], v6, s[36:39], s80 offen sc1
    s_add_u32 s81, s68, 12288
    buffer_load_dwordx4 v[52:55], v6, s[36:39], s81 offen sc1
    buffer_load_dwordx4 v14, s[32:35], s64 offen offset:2048 lds
    buffer_load_dwordx4 v[56:59], v7, s[36:39], s80 offen sc1
    buffer_load_dwordx4 v[60:63], v7, s[36:39], s81 offen sc1
    buffer_load_dwordx4 v15, s[32:35], s64 offen offset:3072 lds
    s_waitcnt vmcnt(13)
    ds_read_b64_tr_b16 a[176:177], v2 offset:0
    ds_read_b64_tr_b16 a[178:179], v2 offset:2048
    ds_read_b64_tr_b16 a[180:181], v3 offset:0
    ds_read_b64_tr_b16 a[182:183], v3 offset:2048
    s_add_u32 s80, s67, 24576
    buffer_load_dwordx4 v[64:67], v6, s[36:39], s80 offen sc1
    ds_read_b64_tr_b16 a[184:185], v4 offset:0
    ds_read_b64_tr_b16 a[186:187], v4 offset:2048
    ds_read_b64_tr_b16 a[188:189], v5 offset:0
    ds_read_b64_tr_b16 a[190:191], v5 offset:2048
    s_lshl2_add_u32 s78, s2, s3
    s_cmpk_eq_u32 s78, 795
    s_cbranch_scc1 L_ep0
L_epb0:
    s_add_u32 s81, s67, 36864
    buffer_load_dwordx4 v[68:71], v6, s[36:39], s81 offen sc1
    s_waitcnt vmcnt(12)
    v_mfma_f32_16x16x32_bf16 v[128:131], a[0:3], v[32:35], 0
    s_add_u32 m0, s12, 81920
    s_add_u32 s64, s71, 262144
    v_mfma_f32_16x16x32_bf16 v[128:131], a[16:19], v[36:39], v[128:131]
    buffer_load_dwordx4 v12, s[32:35], s64 offen offset:0 lds
    v_mfma_f32_16x16x32_bf16 v[132:135], a[20:23], v[36:39], 0
    v_mfma_f32_16x16x32_bf16 v[132:135], a[4:7], v[32:35], v[132:135]
    buffer_load_dwordx4 v[72:75], v7, s[36:39], s80 offen sc1
    v_mfma_f32_16x16x32_bf16 v[136:139], a[8:11], v[32:35], 0
    v_mfma_f32_16x16x32_bf16 v[136:139], a[24:27], v[36:39], v[136:139]
    buffer_load_dwordx4 v[76:79], v7, s[36:39], s81 offen sc1
    v_mfma_f32_16x16x32_bf16 v[140:143], a[28:31], v[36:39], 0
    v_mfma_f32_16x16x32_bf16 v[140:143], a[12:15], v[32:35], v[140:143]
    s_waitcnt vmcnt(12)
    v_mfma_f32_16x16x32_bf16 v[156:159], a[12:15], v[40:43], 0
    v_mfma_f32_16x16x32_bf16 v[156:159], a[28:31], v[44:47], v[156:159]
    buffer_load_dwordx4 v13, s[32:35], s64 offen offset:1024 lds
    v_mfma_f32_16x16x32_bf16 v[152:155], a[24:27], v[44:47], 0
    s_add_u32 s80, s68, 24576
    v_mfma_f32_16x16x32_bf16 v[152:155], a[8:11], v[40:43], v[152:155]
    buffer_load_dwordx4 v[80:83], v6, s[36:39], s80 offen sc1
    v_mfma_f32_16x16x32_bf16 v[148:151], a[4:7], v[40:43], 0
    s_add_u32 s81, s68, 36864
    v_mfma_f32_16x16x32_bf16 v[148:151], a[20:23], v[44:47], v[148:151]
    buffer_load_dwordx4 v[84:87], v6, s[36:39], s81 offen sc1
    v_mfma_f32_16x16x32_bf16 v[144:147], a[16:19], v[44:47], 0
    v_mfma_f32_16x16x32_bf16 v[144:147], a[0:3], v[40:43], v[144:147]
    s_waitcnt vmcnt(12)
    v_mfma_f32_16x16x32_bf16 v[160:163], a[0:3], v[48:51], 0
    v_mfma_f32_16x16x32_bf16 v[160:163], a[16:19], v[52:55], v[160:163]
    buffer_load_dwordx4 v14, s[32:35], s64 offen offset:2048 lds
    v_mfma_f32_16x16x32_bf16 v[164:167], a[20:23], v[52:55], 0
    v_mfma_f32_16x16x32_bf16 v[164:167], a[4:7], v[48:51], v[164:167]
    buffer_load_dwordx4 v[88:91], v7, s[36:39], s80 offen sc1
    v_mfma_f32_16x16x32_bf16 v[168:171], a[8:11], v[48:51], 0
    v_mfma_f32_16x16x32_bf16 v[168:171], a[24:27], v[52:55], v[168:171]
    buffer_load_dwordx4 v[92:95], v7, s[36:39], s81 offen sc1
    v_mfma_f32_16x16x32_bf16 v[172:175], a[28:31], v[52:55], 0
    v_mfma_f32_16x16x32_bf16 v[172:175], a[12:15], v[48:51], v[172:175]
    s_waitcnt vmcnt(12)
    v_mfma_f32_16x16x32_bf16 v[188:191], a[12:15], v[56:59], 0
    v_mfma_f32_16x16x32_bf16 v[188:191], a[28:31], v[60:63], v[188:191]
    buffer_load_dwordx4 v15, s[32:35], s64 offen offset:3072 lds
    v_mfma_f32_16x16x32_bf16 v[184:187], a[24:27], v[60:63], 0
    v_mfma_f32_16x16x32_bf16 v[184:187], a[8:11], v[56:59], v[184:187]
    s_waitcnt vmcnt(12)
    ds_read_b64_tr_b16 a[192:193], v16 offset:32768
    v_mfma_f32_16x16x32_bf16 v[180:183], a[4:7], v[56:59], 0
    ds_read_b64_tr_b16 a[194:195], v16 offset:34816
    ds_read_b64_tr_b16 a[196:197], v17 offset:32768
    v_mfma_f32_16x16x32_bf16 v[180:183], a[20:23], v[60:63], v[180:183]
    ds_read_b64_tr_b16 a[198:199], v17 offset:34816
    s_add_u32 s80, s67, 49152
    v_mfma_f32_16x16x32_bf16 v[176:179], a[16:19], v[60:63], 0
    v_mfma_f32_16x16x32_bf16 v[176:179], a[0:3], v[56:59], v[176:179]
    buffer_load_dwordx4 v[32:35], v6, s[36:39], s80 offen sc1
    ds_read_b64_tr_b16 a[200:201], v18 offset:32768
    ds_read_b64_tr_b16 a[202:203], v18 offset:34816
    ds_read_b64_tr_b16 a[204:205], v19 offset:32768
    ds_read_b64_tr_b16 a[206:207], v19 offset:34816
    s_add_u32 s81, s67, 61440
    buffer_load_dwordx4 v[36:39], v6, s[36:39], s81 offen sc1
    s_waitcnt vmcnt(12)
    v_mfma_f32_16x16x32_bf16 v[128:131], a[32:35], v[64:67], v[128:131]
    v_mfma_f32_16x16x32_bf16 v[128:131], a[48:51], v[68:71], v[128:131]
    v_mfma_f32_16x16x32_bf16 v[132:135], a[52:55], v[68:71], v[132:135]
    v_mfma_f32_16x16x32_bf16 v[132:135], a[36:39], v[64:67], v[132:135]
    v_mfma_f32_16x16x32_bf16 v[136:139], a[40:43], v[64:67], v[136:139]
    v_mfma_f32_16x16x32_bf16 v[136:139], a[56:59], v[68:71], v[136:139]
    v_mfma_f32_16x16x32_bf16 v[140:143], a[60:63], v[68:71], v[140:143]
    v_mfma_f32_16x16x32_bf16 v[140:143], a[44:47], v[64:67], v[140:143]
    s_lshl2_add_u32 s78, s2, s3
    s_cmpk_eq_u32 s78, 795
    s_cbranch_scc1 L_ep1
L_epb1:
    s_waitcnt lgkmcnt(15)
    s_add_u32 m0, s12, 0
    s_add_u32 s64, s71, 393216
    buffer_load_dwordx4 v12, s[32:35], s64 offen offset:0 lds
    buffer_load_dwordx4 v[40:43], v7, s[36:39], s80 offen sc1
    buffer_load_dwordx4 v[44:47], v7, s[36:39], s81 offen sc1
    s_waitcnt vmcnt(12)
    v_mfma_f32_16x16x32_bf16 v[156:159], a[44:47], v[72:75], v[156:159]
    v_mfma_f32_16x16x32_bf16 v[156:159], a[60:63], v[76:79], v[156:159]
    buffer_load_dwordx4 v13, s[32:35], s64 offen offset:1024 lds
    v_mfma_f32_16x16x32_bf16 v[152:155], a[56:59], v[76:79], v[152:155]
    s_add_u32 s80, s68, 49152
    v_mfma_f32_16x16x32_bf16 v[152:155], a[40:43], v[72:75], v[152:155]
    buffer_load_dwordx4 v[48:51], v6, s[36:39], s80 offen sc1
    v_mfma_f32_16x16x32_bf16 v[148:151], a[36:39], v[72:75], v[148:151]
    s_add_u32 s81, s68, 61440
    v_mfma_f32_16x16x32_bf16 v[148:151], a[52:55], v[76:79], v[148:151]
    buffer_load_dwordx4 v[52:55], v6, s[36:39], s81 offen sc1
    v_mfma_f32_16x16x32_bf16 v[144:147], a[48:51], v[76:79], v[144:147]
    v_mfma_f32_16x16x32_bf16 v[144:147], a[32:35], v[72:75], v[144:147]
    s_waitcnt vmcnt(12)
    v_mfma_f32_16x16x32_bf16 v[160:163], a[32:35], v[80:83], v[160:163]
    v_mfma_f32_16x16x32_bf16 v[160:163], a[48:51], v[84:87], v[160:163]
    buffer_load_dwordx4 v14, s[32:35], s64 offen offset:2048 lds
    v_mfma_f32_16x16x32_bf16 v[164:167], a[52:55], v[84:87], v[164:167]
    v_mfma_f32_16x16x32_bf16 v[164:167], a[36:39], v[80:83], v[164:167]
    buffer_load_dwordx4 v[56:59], v7, s[36:39], s80 offen sc1
    v_mfma_f32_16x16x32_bf16 v[168:171], a[40:43], v[80:83], v[168:171]
    v_mfma_f32_16x16x32_bf16 v[168:171], a[56:59], v[84:87], v[168:171]
    buffer_load_dwordx4 v[60:63], v7, s[36:39], s81 offen sc1
    v_mfma_f32_16x16x32_bf16 v[172:175], a[60:63], v[84:87], v[172:175]
    v_mfma_f32_16x16x32_bf16 v[172:175], a[44:47], v[80:83], v[172:175]
    s_waitcnt vmcnt(12)
    v_mfma_f32_16x16x32_bf16 v[188:191], a[44:47], v[88:91], v[188:191]
    v_mfma_f32_16x16x32_bf16 v[188:191], a[60:63], v[92:95], v[188:191]
    buffer_load_dwordx4 v15, s[32:35], s64 offen offset:3072 lds
    v_mfma_f32_16x16x32_bf16 v[184:187], a[56:59], v[92:95], v[184:187]
    v_mfma_f32_16x16x32_bf16 v[184:187], a[40:43], v[88:91], v[184:187]
    s_waitcnt vmcnt(12)
    ds_read_b64_tr_b16 a[208:209], v2 offset:16384
    v_mfma_f32_16x16x32_bf16 v[180:183], a[36:39], v[88:91], v[180:183]
    ds_read_b64_tr_b16 a[210:211], v2 offset:18432
    ds_read_b64_tr_b16 a[212:213], v3 offset:16384
    v_mfma_f32_16x16x32_bf16 v[180:183], a[52:55], v[92:95], v[180:183]
    ds_read_b64_tr_b16 a[214:215], v3 offset:18432
    s_mov_b64 exec, 0xffff
    buffer_load_dword v27, v25, s[36:39], s13 offen offset:0 sc1
    s_mov_b64 exec, -1
    v_mfma_f32_16x16x32_bf16 v[176:179], a[48:51], v[92:95], v[176:179]
    ds_read_b64_tr_b16 a[216:217], v4 offset:16384
    ds_read_b64_tr_b16 a[218:219], v4 offset:18432
    v_mfma_f32_16x16x32_bf16 v[176:179], a[32:35], v[88:91], v[176:179]
    ds_read_b64_tr_b16 a[220:221], v5 offset:16384
    ds_read_b64_tr_b16 a[222:223], v5 offset:18432
    s_add_u32 s80, s67, 73728
    buffer_load_dwordx4 v[64:67], v6, s[36:39], s80 offen sc1
    s_waitcnt vmcnt(12)
    v_mfma_f32_16x16x32_bf16 v[128:131], a[64:67], v[32:35], v[128:131]
    s_add_u32 s81, s67, 86016
    v_mfma_f32_16x16x32_bf16 v[128:131], a[80:83], v[36:39], v[128:131]
    buffer_load_dwordx4 v[68:71], v6, s[36:39], s81 offen sc1
    v_mfma_f32_16x16x32_bf16 v[132:135], a[84:87], v[36:39], v[132:135]
    v_mfma_f32_16x16x32_bf16 v[132:135], a[68:71], v[32:35], v[132:135]
    buffer_load_dwordx4 v[72:75], v7, s[36:39], s80 offen sc1
    v_mfma_f32_16x16x32_bf16 v[136:139], a[72:75], v[32:35], v[136:139]
    v_mfma_f32_16x16x32_bf16 v[136:139], a[88:91], v[36:39], v[136:139]
    buffer_load_dwordx4 v[76:79], v7, s[36:39], s81 offen sc1
    v_mfma_f32_16x16x32_bf16 v[140:143], a[92:95], v[36:39], v[140:143]
    v_mfma_f32_16x16x32_bf16 v[140:143], a[76:79], v[32:35], v[140:143]
    s_waitcnt vmcnt(12)
    v_mfma_f32_16x16x32_bf16 v[156:159], a[76:79], v[40:43], v[156:159]
    s_add_u32 s80, s68, 73728
    v_mfma_f32_16x16x32_bf16 v[156:159], a[92:95], v[44:47], v[156:159]
    buffer_load_dwordx4 v[80:83], v6, s[36:39], s80 offen sc1
    v_mfma_f32_16x16x32_bf16 v[152:155], a[88:91], v[44:47], v[152:155]
    s_add_u32 s81, s68, 86016
    v_mfma_f32_16x16x32_bf16 v[152:155], a[72:75], v[40:43], v[152:155]
    buffer_load_dwordx4 v[84:87], v6, s[36:39], s81 offen sc1
    v_mfma_f32_16x16x32_bf16 v[148:151], a[68:71], v[40:43], v[148:151]
    v_mfma_f32_16x16x32_bf16 v[148:151], a[84:87], v[44:47], v[148:151]
    buffer_load_dwordx4 v[88:91], v7, s[36:39], s80 offen sc1
    v_mfma_f32_16x16x32_bf16 v[144:147], a[80:83], v[44:47], v[144:147]
    v_mfma_f32_16x16x32_bf16 v[144:147], a[64:67], v[40:43], v[144:147]
    s_waitcnt vmcnt(12)
    v_mfma_f32_16x16x32_bf16 v[160:163], a[64:67], v[48:51], v[160:163]
    v_mfma_f32_16x16x32_bf16 v[160:163], a[80:83], v[52:55], v[160:163]
    buffer_load_dwordx4 v[92:95], v7, s[36:39], s81 offen sc1
    v_mfma_f32_16x16x32_bf16 v[164:167], a[84:87], v[52:55], v[164:167]
    v_mfma_f32_16x16x32_bf16 v[164:167], a[68:71], v[48:51], v[164:167]
    v_mfma_f32_16x16x32_bf16 v[168:171], a[72:75], v[48:51], v[168:171]
    v_mfma_f32_16x16x32_bf16 v[168:171], a[88:91], v[52:55], v[168:171]
    v_mfma_f32_16x16x32_bf16 v[172:175], a[92:95], v[52:55], v[172:175]
    v_mfma_f32_16x16x32_bf16 v[172:175], a[76:79], v[48:51], v[172:175]
    s_waitcnt vmcnt(8)
    s_mov_b32 s70, 0
L_f2f_chk:
    v_cmp_ne_u32 vcc, s59, v27
    s_and_b32 s74, vcc_lo, 0xffff
    s_cbranch_scc1 L_f2f_retry
L_f2f_ok:
    v_and_b32 v26, 15, v0
    v_lshlrev_b32 v26, 3, v26
    s_xor_b32 s78, s9, 0
    buffer_load_dword v20, v26, s[36:39], s78 offen sc1
    s_xor_b32 s78, s9, 128
    buffer_load_dword v21, v26, s[36:39], s78 offen sc1
    v_mfma_f32_16x16x32_bf16 v[188:191], a[76:79], v[56:59], v[188:191]
    s_xor_b32 s78, s9, 256
    v_mfma_f32_16x16x32_bf16 v[188:191], a[92:95], v[60:63], v[188:191]
    buffer_load_dword v22, v26, s[36:39], s78 offen sc1
    v_mfma_f32_16x16x32_bf16 v[184:187], a[88:91], v[60:63], v[184:187]
    ds_read_b64_tr_b16 a[224:225], v16 offset:0
    ds_read_b64_tr_b16 a[226:227], v16 offset:2048
    v_mfma_f32_16x16x32_bf16 v[184:187], a[72:75], v[56:59], v[184:187]
    ds_read_b64_tr_b16 a[228:229], v17 offset:0
    ds_read_b64_tr_b16 a[230:231], v17 offset:2048
    v_mfma_f32_16x16x32_bf16 v[180:183], a[68:71], v[56:59], v[180:183]
    s_xor_b32 s78, s9, 384
    v_mfma_f32_16x16x32_bf16 v[180:183], a[84:87], v[60:63], v[180:183]
    buffer_load_dword v30, v26, s[36:39], s78 offen sc1
    v_mfma_f32_16x16x32_bf16 v[176:179], a[80:83], v[60:63], v[176:179]
    ds_read_b64_tr_b16 a[232:233], v18 offset:0
    ds_read_b64_tr_b16 a[234:235], v18 offset:2048
    v_mfma_f32_16x16x32_bf16 v[176:179], a[64:67], v[56:59], v[176:179]
    ds_read_b64_tr_b16 a[236:237], v19 offset:0
    ds_read_b64_tr_b16 a[238:239], v19 offset:2048
    s_add_u32 s80, s68, 98304
    buffer_load_dwordx4 v[32:35], v7, s[36:39], s80 offen sc1
    s_add_u32 s81, s68, 110592
    buffer_load_dwordx4 v[36:39], v7, s[36:39], s81 offen sc1
    s_waitcnt vmcnt(12)
    v_mfma_f32_16x16x32_bf16 v[128:131], a[96:99], v[64:67], v[128:131]
    s_add_u32 s80, s68, 122880
    s_cmp_eq_u32 s3, 3
    v_mfma_f32_16x16x32_bf16 v[128:131], a[112:115], v[68:71], v[128:131]
    s_cselect_b32 s80, 1073741824, s80
    buffer_load_dwordx4 v[40:43], v7, s[36:39], s80 offen sc1
    v_mfma_f32_16x16x32_bf16 v[132:135], a[116:119], v[68:71], v[132:135]
    s_add_u32 s80, s68, 98304
    v_mfma_f32_16x16x32_bf16 v[132:135], a[100:103], v[64:67], v[132:135]
    buffer_load_dwordx4 v[44:47], v6, s[36:39], s80 offen sc1
    v_mfma_f32_16x16x32_bf16 v[136:139], a[104:107], v[64:67], v[136:139]
    v_mfma_f32_16x16x32_bf16 v[136:139], a[120:123], v[68:71], v[136:139]
    v_mfma_f32_16x16x32_bf16 v[140:143], a[124:127], v[68:71], v[140:143]
    v_mfma_f32_16x16x32_bf16 v[140:143], a[108:111], v[64:67], v[140:143]
    s_waitcnt vmcnt(12)
    v_mfma_f32_16x16x32_bf16 v[156:159], a[108:111], v[72:75], v[156:159]
    v_mov_b32 v28, 0
    v_mfma_f32_16x16x32_bf16 v[156:159], a[124:127], v[76:79], v[156:159]
    s_mov_b64 exec, 0xffff
    buffer_atomic_or v28, v25, s[36:39], s8 offen offset:0 sc0 sc1
    s_mov_b64 exec, -1
    v_mfma_f32_16x16x32_bf16 v[152:155], a[120:123], v[76:79], v[152:155]
    s_add_u32 s81, s68, 110592
    v_mfma_f32_16x16x32_bf16 v[152:155], a[104:107], v[72:75], v[152:155]
    buffer_load_dwordx4 v[48:51], v6, s[36:39], s81 offen sc1
    v_mfma_f32_16x16x32_bf16 v[148:151], a[100:103], v[72:75], v[148:151]
    v_mfma_f32_16x16x32_bf16 v[148:151], a[116:119], v[76:79], v[148:151]
    v_mfma_f32_16x16x32_bf16 v[144:147], a[112:115], v[76:79], v[144:147]
    v_mfma_f32_16x16x32_bf16 v[144:147], a[96:99], v[72:75], v[144:147]
    s_waitcnt vmcnt(12)
    v_mov_b32 v122, s3
    v_mfma_f32_16x16x32_bf16 v[160:163], a[96:99], v[80:83], v[160:163]
    s_add_u32 s80, s68, 122880
    s_cmp_eq_u32 s3, 3
    v_mfma_f32_16x16x32_bf16 v[160:163], a[112:115], v[84:87], v[160:163]
    s_cselect_b32 s80, 1073741824, s80
    buffer_load_dwordx4 v[52:55], v6, s[36:39], s80 offen sc1
    v_mfma_f32_16x16x32_bf16 v[164:167], a[116:119], v[84:87], v[164:167]
    s_add_u32 s80, s67, 98304
    v_lshl_add_u32 v8, v122, 14, v24
    v_mfma_f32_16x16x32_bf16 v[164:167], a[100:103], v[80:83], v[164:167]
    buffer_load_dwordx4 v[56:59], v7, s[36:39], s80 offen sc1
    v_mfma_f32_16x16x32_bf16 v[168:171], a[104:107], v[80:83], v[168:171]
    v_xor_b32 v10, 32768, v8
    v_add_u32 v8, 98304, v8
    v_mfma_f32_16x16x32_bf16 v[168:171], a[120:123], v[84:87], v[168:171]
    v_add_u32 v10, 98304, v10
    v_xor_b32 v9, 16384, v8
    v_mfma_f32_16x16x32_bf16 v[172:175], a[124:127], v[84:87], v[172:175]
    v_xor_b32 v11, 16384, v10
    v_lshl_add_u32 v122, s55, 2, v122
    v_mfma_f32_16x16x32_bf16 v[172:175], a[108:111], v[80:83], v[172:175]
    s_waitcnt vmcnt(12)
    v_lshrrev_b32 v121, 3, v0
    v_mfma_f32_16x16x32_bf16 v[188:191], a[108:111], v[88:91], v[188:191]
    s_add_u32 s81, s67, 110592
    v_lshl_add_u32 v29, v122, 4, v121
    v_mfma_f32_16x16x32_bf16 v[188:191], a[124:127], v[92:95], v[188:191]
    buffer_load_dwordx4 v[60:63], v7, s[36:39], s81 offen sc1
    v_mfma_f32_16x16x32_bf16 v[184:187], a[120:123], v[92:95], v[184:187]
    s_add_u32 s80, s67, 122880
    s_cmp_eq_u32 s3, 3
    v_mfma_f32_16x16x32_bf16 v[184:187], a[104:107], v[88:91], v[184:187]
    s_cselect_b32 s80, 1073741824, s80
    buffer_load_dwordx4 v[64:67], v7, s[36:39], s80 offen sc1
    v_mfma_f32_16x16x32_bf16 v[180:183], a[100:103], v[88:91], v[180:183]
    s_add_u32 s80, s67, 98304
    v_lshl_add_u32 v29, v29, 3, s56
    v_mfma_f32_16x16x32_bf16 v[180:183], a[116:119], v[92:95], v[180:183]
    buffer_load_dwordx4 v[68:71], v6, s[36:39], s80 offen sc1
    v_mfma_f32_16x16x32_bf16 v[176:179], a[112:115], v[92:95], v[176:179]
    v_lshlrev_b32 v29, 7, v29
    v_and_b32 v122, 7, v0
    v_mfma_f32_16x16x32_bf16 v[176:179], a[96:99], v[88:91], v[176:179]
    s_waitcnt vmcnt(8)
    v_lshl_add_u32 v29, v122, 4, v29
    v_mfma_f32_16x16x32_bf16 v[188:191], a[140:143], v[32:35], v[188:191]
    s_add_u32 s81, s67, 110592
    v_lshl_add_u32 v121, v121, 4, v8
    v_mfma_f32_16x16x32_bf16 v[188:191], a[156:159], v[36:39], v[188:191]
    v_add_u32 v121, 12288, v121
    v_and_b32 v122, 15, v0
    v_mfma_f32_16x16x32_bf16 v[188:191], a[172:175], v[40:43], v[188:191]
    buffer_load_dwordx4 v[72:75], v6, s[36:39], s81 offen sc1
    v_mfma_f32_16x16x32_bf16 v[184:187], a[168:171], v[40:43], v[184:187]
    s_add_u32 s80, s67, 122880
    s_cmp_eq_u32 s3, 3
    v_mfma_f32_16x16x32_bf16 v[184:187], a[152:155], v[36:39], v[184:187]
    s_cselect_b32 s80, 1073741824, s80
    v_lshl_add_u32 v123, v122, 7, v8
    v_mfma_f32_16x16x32_bf16 v[184:187], a[136:139], v[32:35], v[184:187]
    buffer_load_dwordx4 v[76:79], v6, s[36:39], s80 offen sc1
    v_mfma_f32_16x16x32_bf16 v[180:183], a[132:135], v[32:35], v[180:183]
    v_lshrrev_b32 v122, 4, v0
    v_mul_u32_u24 v122, 248, v122
    v_mfma_f32_16x16x32_bf16 v[180:183], a[148:151], v[36:39], v[180:183]
    v_sub_u32 v123, v123, v122
    v_add_u32 v123, 12288, v123
    v_mfma_f32_16x16x32_bf16 v[180:183], a[164:167], v[40:43], v[180:183]
    v_mfma_f32_16x16x32_bf16 v[176:179], a[160:163], v[40:43], v[176:179]
    v_mfma_f32_16x16x32_bf16 v[176:179], a[144:147], v[36:39], v[176:179]
    v_mfma_f32_16x16x32_bf16 v[176:179], a[128:131], v[32:35], v[176:179]
    s_waitcnt vmcnt(8)
    s_mov_b32 s70, 0
L_paf_chk:
    v_cmp_ne_u32 vcc, s59, v28
    s_and_b32 s74, vcc_lo, s11
    s_cbranch_scc1 L_paf_retry
L_paf_ok:
    s_add_u32 s80, s68, 132096
    buffer_load_dwordx4 v[80:83], v7, s[36:39], s80 offen sc1
    s_add_u32 s80, s68, 144384
    buffer_load_dwordx4 v[84:87], v7, s[36:39], s80 offen sc1
    s_waitcnt vmcnt(8)
    v_mfma_f32_16x16x32_bf16 v[160:163], a[128:131], v[44:47], v[160:163]
    s_add_u32 s80, s68, 156672
    v_sub_f32 v26, 1.0, v30
    v_mfma_f32_16x16x32_bf16 v[160:163], a[144:147], v[48:51], v[160:163]
    v_mul_f32 v191, v191, v26
    v_mul_f32 v190, v190, v26
    v_mfma_f32_16x16x32_bf16 v[160:163], a[160:163], v[52:55], v[160:163]
    buffer_load_dwordx4 v[88:91], v7, s[36:39], s80 offen sc1
    v_mfma_f32_16x16x32_bf16 v[164:167], a[164:167], v[52:55], v[164:167]
    s_add_u32 s80, s68, 168960
    v_mul_f32 v189, v189, v26
    v_mfma_f32_16x16x32_bf16 v[164:167], a[148:151], v[48:51], v[164:167]
    v_mul_f32 v188, v188, v26
    v_mul_f32 v187, v187, v26
    v_mfma_f32_16x16x32_bf16 v[164:167], a[132:135], v[44:47], v[164:167]
    buffer_load_dwordx4 v[92:95], v7, s[36:39], s80 offen sc1
    v_mfma_f32_16x16x32_bf16 v[168:171], a[136:139], v[44:47], v[168:171]
    s_add_u32 s80, s68, 132096
    v_mul_f32 v186, v186, v26
    v_mfma_f32_16x16x32_bf16 v[168:171], a[152:155], v[48:51], v[168:171]
    v_mul_f32 v185, v185, v26
    v_mul_f32 v184, v184, v26
    v_mfma_f32_16x16x32_bf16 v[168:171], a[168:171], v[52:55], v[168:171]
    buffer_load_dwordx4 v[32:35], v6, s[36:39], s80 offen sc1
    v_mfma_f32_16x16x32_bf16 v[172:175], a[172:175], v[52:55], v[172:175]
    v_mul_f32 v183, v183, v26
    v_mul_f32 v182, v182, v26
    v_mfma_f32_16x16x32_bf16 v[172:175], a[156:159], v[48:51], v[172:175]
    v_mul_f32 v181, v181, v26
    v_mul_f32 v180, v180, v26
    v_mfma_f32_16x16x32_bf16 v[172:175], a[140:143], v[44:47], v[172:175]
    s_waitcnt vmcnt(8)
    v_mul_f32 v179, v179, v26
    v_mfma_f32_16x16x32_bf16 v[156:159], a[140:143], v[56:59], v[156:159]
    s_add_u32 s80, s68, 144384
    v_mul_f32 v178, v178, v26
    v_mfma_f32_16x16x32_bf16 v[156:159], a[156:159], v[60:63], v[156:159]
    v_mul_f32 v177, v177, v26
    v_mul_f32 v176, v176, v26
    v_mfma_f32_16x16x32_bf16 v[156:159], a[172:175], v[64:67], v[156:159]
    buffer_load_dwordx4 v[36:39], v6, s[36:39], s80 offen sc1
    v_mfma_f32_16x16x32_bf16 v[152:155], a[168:171], v[64:67], v[152:155]
    s_add_u32 s80, s68, 156672
    v_sub_f32 v26, 1.0, v22
    v_mfma_f32_16x16x32_bf16 v[152:155], a[152:155], v[60:63], v[152:155]
    v_mul_f32 v160, v160, v26
    v_mul_f32 v161, v161, v26
    v_mfma_f32_16x16x32_bf16 v[152:155], a[136:139], v[56:59], v[152:155]
    buffer_load_dwordx4 v[40:43], v6, s[36:39], s80 offen sc1
    v_mfma_f32_16x16x32_bf16 v[148:151], a[132:135], v[56:59], v[148:151]
    s_add_u32 s80, s68, 168960
    v_mul_f32 v162, v162, v26
    v_mfma_f32_16x16x32_bf16 v[148:151], a[148:151], v[60:63], v[148:151]
    v_mul_f32 v163, v163, v26
    v_mul_f32 v164, v164, v26
    v_mfma_f32_16x16x32_bf16 v[148:151], a[164:167], v[64:67], v[148:151]
    buffer_load_dwordx4 v[44:47], v6, s[36:39], s80 offen sc1
    v_mfma_f32_16x16x32_bf16 v[144:147], a[160:163], v[64:67], v[144:147]
    v_mul_f32 v165, v165, v26
    v_mul_f32 v166, v166, v26
    v_mfma_f32_16x16x32_bf16 v[144:147], a[144:147], v[60:63], v[144:147]
    v_mul_f32 v167, v167, v26
    v_mul_f32 v168, v168, v26
    v_mfma_f32_16x16x32_bf16 v[144:147], a[128:131], v[56:59], v[144:147]
    s_waitcnt vmcnt(8)
    v_mul_f32 v169, v169, v26
    v_mfma_f32_16x16x32_bf16 v[128:131], a[128:131], v[68:71], v[128:131]
    s_add_u32 s80, s67, 132096
    v_mul_f32 v170, v170, v26
    v_mfma_f32_16x16x32_bf16 v[128:131], a[144:147], v[72:75], v[128:131]
    v_mul_f32 v171, v171, v26
    v_mul_f32 v172, v172, v26
    v_mfma_f32_16x16x32_bf16 v[128:131], a[160:163], v[76:79], v[128:131]
    buffer_load_dwordx4 v[48:51], v7, s[36:39], s80 offen sc1
    v_mfma_f32_16x16x32_bf16 v[132:135], a[164:167], v[76:79], v[132:135]
    s_add_u32 s80, s67, 144384
    v_mul_f32 v173, v173, v26
    v_mfma_f32_16x16x32_bf16 v[132:135], a[148:151], v[72:75], v[132:135]
    v_mul_f32 v174, v174, v26
    v_mul_f32 v175, v175, v26
    v_mfma_f32_16x16x32_bf16 v[132:135], a[132:135], v[68:71], v[132:135]
    buffer_load_dwordx4 v[52:55], v7, s[36:39], s80 offen sc1
    v_mfma_f32_16x16x32_bf16 v[136:139], a[136:139], v[68:71], v[136:139]
    v_sub_f32 v26, 1.0, v21
    v_mul_f32 v159, v159, v26
    v_mfma_f32_16x16x32_bf16 v[136:139], a[152:155], v[72:75], v[136:139]
    v_mul_f32 v158, v158, v26
    v_mul_f32 v157, v157, v26
    v_mfma_f32_16x16x32_bf16 v[136:139], a[168:171], v[76:79], v[136:139]
    v_mul_f32 v156, v156, v26
    v_mul_f32 v155, v155, v26
    v_mfma_f32_16x16x32_bf16 v[140:143], a[172:175], v[76:79], v[140:143]
    v_mul_f32 v154, v154, v26
    v_mul_f32 v153, v153, v26
    v_mfma_f32_16x16x32_bf16 v[140:143], a[156:159], v[72:75], v[140:143]
    v_mul_f32 v152, v152, v26
    v_mul_f32 v151, v151, v26
    v_mfma_f32_16x16x32_bf16 v[140:143], a[140:143], v[68:71], v[140:143]
    s_waitcnt vmcnt(8) lgkmcnt(15)
    v_mul_f32 v150, v150, v26
    v_mfma_f32_16x16x32_bf16 v[188:191], a[188:191], v[80:83], v[188:191]
    s_add_u32 s80, s67, 156672
    v_mul_f32 v149, v149, v26
    v_mfma_f32_16x16x32_bf16 v[188:191], a[204:207], v[84:87], v[188:191]
    buffer_load_dwordx4 v[56:59], v7, s[36:39], s80 offen sc1
    v_mfma_f32_16x16x32_bf16 v[184:187], a[200:203], v[84:87], v[184:187]
    s_add_u32 s80, s67, 168960
    v_mul_f32 v148, v148, v26
    v_mfma_f32_16x16x32_bf16 v[184:187], a[184:187], v[80:83], v[184:187]
    buffer_load_dwordx4 v[60:63], v7, s[36:39], s80 offen sc1
    v_mfma_f32_16x16x32_bf16 v[180:183], a[180:183], v[80:83], v[180:183]
    v_mul_f32 v147, v147, v26
    v_mul_f32 v146, v146, v26
    v_mfma_f32_16x16x32_bf16 v[180:183], a[196:199], v[84:87], v[180:183]
    v_mul_f32 v145, v145, v26
    v_mul_f32 v144, v144, v26
    v_mfma_f32_16x16x32_bf16 v[176:179], a[192:195], v[84:87], v[176:179]
    v_sub_f32 v26, 1.0, v20
    v_mul_f32 v128, v128, v26
    v_mfma_f32_16x16x32_bf16 v[176:179], a[176:179], v[80:83], v[176:179]
    s_waitcnt vmcnt(8) lgkmcnt(0)
    v_mul_f32 v129, v129, v26
    v_mfma_f32_16x16x32_bf16 v[188:191], a[220:223], v[88:91], v[188:191]
    s_add_u32 s80, s67, 132096
    v_mul_f32 v130, v130, v26
    v_mfma_f32_16x16x32_bf16 v[188:191], a[236:239], v[92:95], v[188:191]
    buffer_load_dwordx4 v[64:67], v6, s[36:39], s80 offen sc1
    v_mfma_f32_16x16x32_bf16 v[184:187], a[232:235], v[92:95], v[184:187]
    s_add_u32 s80, s67, 144384
    v_mul_f32 v131, v131, v26
    v_mfma_f32_16x16x32_bf16 v[184:187], a[216:219], v[88:91], v[184:187]
    buffer_load_dwordx4 v[68:71], v6, s[36:39], s80 offen sc1
    v_mfma_f32_16x16x32_bf16 v[180:183], a[212:215], v[88:91], v[180:183]
    v_mul_f32 v132, v132, v26
    v_mul_f32 v133, v133, v26
    v_mfma_f32_16x16x32_bf16 v[180:183], a[228:231], v[92:95], v[180:183]
    v_mul_f32 v134, v134, v26
    v_mul_f32 v135, v135, v26
    v_mfma_f32_16x16x32_bf16 v[176:179], a[224:227], v[92:95], v[176:179]
    v_mul_f32 v136, v136, v26
    v_mul_f32 v137, v137, v26
    v_mfma_f32_16x16x32_bf16 v[176:179], a[208:211], v[88:91], v[176:179]
    s_waitcnt vmcnt(8)
    v_mul_f32 v138, v138, v26
    v_mfma_f32_16x16x32_bf16 v[160:163], a[176:179], v[32:35], v[160:163]
    s_add_u32 s80, s67, 156672
    v_mul_f32 v139, v139, v26
    v_mfma_f32_16x16x32_bf16 v[160:163], a[192:195], v[36:39], v[160:163]
    buffer_load_dwordx4 v[72:75], v6, s[36:39], s80 offen sc1
    v_mfma_f32_16x16x32_bf16 v[164:167], a[196:199], v[36:39], v[164:167]
    s_add_u32 s80, s67, 168960
    v_mul_f32 v140, v140, v26
    v_mfma_f32_16x16x32_bf16 v[164:167], a[180:183], v[32:35], v[164:167]
    buffer_load_dwordx4 v[76:79], v6, s[36:39], s80 offen sc1
    v_mfma_f32_16x16x32_bf16 v[168:171], a[184:187], v[32:35], v[168:171]
    v_mul_f32 v141, v141, v26
    v_mul_f32 v142, v142, v26
    v_mfma_f32_16x16x32_bf16 v[168:171], a[200:203], v[36:39], v[168:171]
    v_mul_f32 v143, v143, v26
    ds_write_b128 v11, v[188:191] offset:11264
    v_mfma_f32_16x16x32_bf16 v[172:175], a[204:207], v[36:39], v[172:175]
    v_mfma_f32_16x16x32_bf16 v[172:175], a[188:191], v[32:35], v[172:175]
    s_waitcnt vmcnt(8)
    ds_write_b128 v11, v[184:187] offset:10240
    v_mfma_f32_16x16x32_bf16 v[160:163], a[208:211], v[40:43], v[160:163]
    v_mfma_f32_16x16x32_bf16 v[160:163], a[224:227], v[44:47], v[160:163]
    ds_write_b128 v11, v[180:183] offset:9216
    v_mfma_f32_16x16x32_bf16 v[164:167], a[228:231], v[44:47], v[164:167]
    v_mfma_f32_16x16x32_bf16 v[164:167], a[212:215], v[40:43], v[164:167]
    ds_write_b128 v11, v[176:179] offset:8192
    v_mfma_f32_16x16x32_bf16 v[168:171], a[216:219], v[40:43], v[168:171]
    v_mfma_f32_16x16x32_bf16 v[168:171], a[232:235], v[44:47], v[168:171]
    v_mfma_f32_16x16x32_bf16 v[172:175], a[236:239], v[44:47], v[172:175]
    v_mfma_f32_16x16x32_bf16 v[172:175], a[220:223], v[40:43], v[172:175]
    s_waitcnt vmcnt(6)
    ds_write_b128 v10, v[160:163] offset:4096
    v_mfma_f32_16x16x32_bf16 v[156:159], a[188:191], v[48:51], v[156:159]
    v_mfma_f32_16x16x32_bf16 v[156:159], a[204:207], v[52:55], v[156:159]
    ds_write_b128 v10, v[164:167] offset:5120
    v_mfma_f32_16x16x32_bf16 v[152:155], a[200:203], v[52:55], v[152:155]
    v_mfma_f32_16x16x32_bf16 v[152:155], a[184:187], v[48:51], v[152:155]
    ds_write_b128 v10, v[168:171] offset:6144
    v_mfma_f32_16x16x32_bf16 v[148:151], a[180:183], v[48:51], v[148:151]
    v_mfma_f32_16x16x32_bf16 v[148:151], a[196:199], v[52:55], v[148:151]
    ds_write_b128 v10, v[172:175] offset:7168
    v_mfma_f32_16x16x32_bf16 v[144:147], a[192:195], v[52:55], v[144:147]
    v_mfma_f32_16x16x32_bf16 v[144:147], a[176:179], v[48:51], v[144:147]
    s_waitcnt vmcnt(4)
    v_mfma_f32_16x16x32_bf16 v[156:159], a[220:223], v[56:59], v[156:159]
    v_mfma_f32_16x16x32_bf16 v[156:159], a[236:239], v[60:63], v[156:159]
    v_mfma_f32_16x16x32_bf16 v[152:155], a[232:235], v[60:63], v[152:155]
    v_mfma_f32_16x16x32_bf16 v[152:155], a[216:219], v[56:59], v[152:155]
    v_mfma_f32_16x16x32_bf16 v[148:151], a[212:215], v[56:59], v[148:151]
    v_mfma_f32_16x16x32_bf16 v[148:151], a[228:231], v[60:63], v[148:151]
    v_mfma_f32_16x16x32_bf16 v[144:147], a[224:227], v[60:63], v[144:147]
    v_mfma_f32_16x16x32_bf16 v[144:147], a[208:211], v[56:59], v[144:147]
    s_waitcnt vmcnt(2)
    v_mfma_f32_16x16x32_bf16 v[128:131], a[176:179], v[64:67], v[128:131]
    v_mfma_f32_16x16x32_bf16 v[128:131], a[192:195], v[68:71], v[128:131]
    ds_write_b128 v9, v[156:159] offset:3072
    v_mfma_f32_16x16x32_bf16 v[132:135], a[196:199], v[68:71], v[132:135]
    v_mfma_f32_16x16x32_bf16 v[132:135], a[180:183], v[64:67], v[132:135]
    ds_write_b128 v9, v[152:155] offset:2048
    v_mfma_f32_16x16x32_bf16 v[136:139], a[184:187], v[64:67], v[136:139]
    v_mfma_f32_16x16x32_bf16 v[136:139], a[200:203], v[68:71], v[136:139]
    ds_write_b128 v9, v[148:151] offset:1024
    v_mfma_f32_16x16x32_bf16 v[140:143], a[204:207], v[68:71], v[140:143]
    v_mfma_f32_16x16x32_bf16 v[140:143], a[188:191], v[64:67], v[140:143]
    ds_write_b128 v9, v[144:147] offset:0
    s_waitcnt lgkmcnt(0)
    s_barrier
    s_waitcnt vmcnt(0)
    v_mfma_f32_16x16x32_bf16 v[128:131], a[208:211], v[72:75], v[128:131]
    ds_read_b128 v[96:99], v8 offset:0
    ds_read_b128 v[192:195], v8 offset:4096
    v_mfma_f32_16x16x32_bf16 v[128:131], a[224:227], v[76:79], v[128:131]
    ds_read_b128 v[32:35], v8 offset:8192
    ds_read_b128 v[100:103], v8 offset:1024
    v_mfma_f32_16x16x32_bf16 v[132:135], a[228:231], v[76:79], v[132:135]
    ds_read_b128 v[196:199], v8 offset:5120
    ds_read_b128 v[36:39], v8 offset:9216
    v_mfma_f32_16x16x32_bf16 v[132:135], a[212:215], v[72:75], v[132:135]
    ds_read_b128 v[104:107], v8 offset:2048
    ds_read_b128 v[200:203], v8 offset:6144
    v_mfma_f32_16x16x32_bf16 v[136:139], a[216:219], v[72:75], v[136:139]
    ds_read_b128 v[40:43], v8 offset:10240
    ds_read_b128 v[108:111], v8 offset:3072
    v_mfma_f32_16x16x32_bf16 v[136:139], a[232:235], v[76:79], v[136:139]
    ds_read_b128 v[204:207], v8 offset:7168
    ds_read_b128 v[44:47], v8 offset:11264
    v_mfma_f32_16x16x32_bf16 v[140:143], a[236:239], v[76:79], v[140:143]
    v_mfma_f32_16x16x32_bf16 v[140:143], a[220:223], v[72:75], v[140:143]
    s_waitcnt lgkmcnt(9)
    v_pk_add_f32 v[96:97], v[96:97], v[192:193]
    v_pk_add_f32 v[98:99], v[98:99], v[194:195]
    v_pk_add_f32 v[128:129], v[128:129], v[32:33]
    v_pk_add_f32 v[130:131], v[130:131], v[34:35]
    v_pk_add_f32 v[128:129], v[128:129], v[96:97]
    v_pk_add_f32 v[130:131], v[130:131], v[98:99]
    v_cvt_pk_bf16_f32 v48, v128, v129
    v_cvt_pk_bf16_f32 v49, v130, v131
    ds_write_b64 v123, v[48:49] offset:0
    s_waitcnt lgkmcnt(7)
    v_pk_add_f32 v[100:101], v[100:101], v[196:197]
    v_pk_add_f32 v[102:103], v[102:103], v[198:199]
    v_pk_add_f32 v[132:133], v[132:133], v[36:37]
    v_pk_add_f32 v[134:135], v[134:135], v[38:39]
    v_pk_add_f32 v[132:133], v[132:133], v[100:101]
    v_pk_add_f32 v[134:135], v[134:135], v[102:103]
    v_cvt_pk_bf16_f32 v50, v132, v133
    v_cvt_pk_bf16_f32 v51, v134, v135
    ds_write_b64 v123, v[50:51] offset:32
    s_waitcnt lgkmcnt(5)
    v_pk_add_f32 v[104:105], v[104:105], v[200:201]
    v_pk_add_f32 v[106:107], v[106:107], v[202:203]
    v_pk_add_f32 v[136:137], v[136:137], v[40:41]
    v_pk_add_f32 v[138:139], v[138:139], v[42:43]
    v_pk_add_f32 v[136:137], v[136:137], v[104:105]
    v_pk_add_f32 v[138:139], v[138:139], v[106:107]
    v_cvt_pk_bf16_f32 v52, v136, v137
    v_cvt_pk_bf16_f32 v53, v138, v139
    ds_write_b64 v123, v[52:53] offset:64
    s_waitcnt lgkmcnt(3)
    v_pk_add_f32 v[108:109], v[108:109], v[204:205]
    v_pk_add_f32 v[110:111], v[110:111], v[206:207]
    v_pk_add_f32 v[140:141], v[140:141], v[44:45]
    v_pk_add_f32 v[142:143], v[142:143], v[46:47]
    v_pk_add_f32 v[140:141], v[140:141], v[108:109]
    v_pk_add_f32 v[142:143], v[142:143], v[110:111]
    v_cvt_pk_bf16_f32 v54, v140, v141
    v_cvt_pk_bf16_f32 v55, v142, v143
    ds_write_b64 v123, v[54:55] offset:96
    ds_read_b128 v[56:59], v121 offset:0
    ds_read_b128 v[60:63], v121 offset:1152
    s_movk_i32 s76, 8192
    s_waitcnt lgkmcnt(1)
    buffer_store_dwordx4 v[56:59], v29, s[40:43], 0 offen sc1
    s_waitcnt lgkmcnt(0)
    buffer_store_dwordx4 v[60:63], v29, s[40:43], s76 offen sc1
    s_endpgm
L_f1f_retry:
    s_add_u32 s70, s70, 1
    s_cmp_gt_u32 s70, 0x8000
    s_cbranch_scc1 L_f1f_ok
    v_mov_b32 v28, 0
    s_mov_b64 exec, 0xffff
    buffer_atomic_or v28, v25, s[36:39], s88 offen offset:0 sc0 sc1
    s_mov_b64 exec, -1
    s_waitcnt vmcnt(0)
    s_branch L_f1f_chk
L_ep0:
    v_lshrrev_b32 v8, 2, v0
    v_lshlrev_b32 v8, 10, v8
    v_and_b32 v9, 3, v0
    v_lshl_add_u32 v8, v9, 3, v8
    v_add_u32 v8, 1835008, v8
    v_lshrrev_b32 v9, 3, v0
    v_lshlrev_b32 v9, 10, v9
    v_and_b32 v10, 7, v0
    v_lshl_add_u32 v9, v10, 3, v9
    v_add_u32 v9, 1867776, v9
    v_mov_b32 v112, 0
    v_mov_b32 v113, 0
    v_mov_b32 v114, 0
    v_mov_b32 v115, 0
    buffer_atomic_or_x2 v[112:113], v8, s[36:39], 0 offen sc0 sc1
    buffer_atomic_or_x2 v[114:115], v9, s[36:39], 0 offen sc0 sc1
    s_branch L_epb0
L_ep1:
    s_mov_b32 s70, 0
L_ep3:
    v_cmp_ne_u32 vcc, s59, v112
    v_cmp_ne_u32 s[74:75], s59, v113
    s_or_b64 vcc, vcc, s[74:75]
    v_cmp_ne_u32 s[74:75], s59, v114
    s_or_b64 vcc, vcc, s[74:75]
    v_cmp_ne_u32 s[74:75], s59, v115
    s_or_b64 vcc, vcc, s[74:75]
    s_cbranch_scc0 L_ep2
    s_add_u32 s70, s70, 1
    s_cmp_gt_u32 s70, 0x8000
    s_cbranch_scc1 L_ep2
    v_mov_b32 v112, 0
    v_mov_b32 v113, 0
    v_mov_b32 v114, 0
    v_mov_b32 v115, 0
    buffer_atomic_or_x2 v[112:113], v8, s[36:39], 0 offen sc0 sc1
    buffer_atomic_or_x2 v[114:115], v9, s[36:39], 0 offen sc0 sc1
    s_waitcnt vmcnt(0)
    s_branch L_ep3
L_ep2:
    s_mov_b64 exec, 0xffff
    buffer_store_dword v1, v25, s[36:39], 0 offen sc1
    s_mov_b64 exec, -1
    s_branch L_epb1
L_f2f_retry:
    s_add_u32 s70, s70, 1
    s_cmp_gt_u32 s70, 0x8000
    s_cbranch_scc1 L_f2f_ok
    v_mov_b32 v27, 0
    s_mov_b64 exec, 0xffff
    buffer_atomic_or v27, v25, s[36:39], s13 offen offset:0 sc0 sc1
    s_mov_b64 exec, -1
    s_waitcnt vmcnt(0)
    s_branch L_f2f_chk
L_paf_retry:
    s_add_u32 s70, s70, 1
    s_cmp_gt_u32 s70, 0x8000
    s_cbranch_scc1 L_paf_ok
    v_mov_b32 v28, 0
    s_mov_b64 exec, 0xffff
    buffer_atomic_or v28, v25, s[36:39], s8 offen offset:0 sc0 sc1
    s_mov_b64 exec, -1
    s_waitcnt vmcnt(0)
    s_branch L_paf_chk
L_attn:
    s_lshl1_add_u32 s76, s49, s58
    s_mul_i32 s86, s76, 49152
    s_add_u32 s86, s86, 131072
    s_mul_i32 s77, s48, 3072
    s_add_u32 s5, s86, s77
    s_lshl_b32 s77, s48, 6
    s_add_u32 s86, s86, s77
    s_lshl_b32 s87, s76, 12
    s_add_u32 s87, s87, 32768
    s_lshl_b32 s78, s76, 9
    s_lshl2_add_u32 s6, s48, s78
    s_and_b32 s79, s48, 3
    s_lshl_b32 s79, s79, 7
    s_add_u32 s7, s78, s79
    s_add_u32 s7, s7, 1867776
    s_add_u32 s76, s76, 43
    s_mul_i32 s76, s76, 3072
    s_add_u32 s82, s66, s76
    s_add_u32 s83, s82, 181248
    s_lshl_b32 s84, s48, 7
    s_add_u32 s84, s84, s87
    v_lshrrev_b32 v26, 2, v0
    v_mul_u32_u24 v26, 3072, v26
    v_and_b32 v27, 3, v0
    v_lshl_add_u32 v88, v27, 4, v26
    v_lshlrev_b32 v26, 6, v27
    v_and_b32 v27, 12, v0
    v_add_u32 v26, v26, v27
    v_and_b32 v27, 1, v0
    v_lshlrev_b32 v27, 3, v27
    v_cmp_gt_u32 vcc, 16, v0
    v_add_u32 v27, 16, v27
    s_mul_i32 s76, s58, 24576
    v_cndmask_b32 v90, v27, v26, vcc
    s_add_u32 s76, s76, 20480
    v_add_u32 v89, s76, v24
    v_mov_b32 v68, 0x3f803f80
    v_mov_b32 v69, 0x3f803f80
    v_mov_b32 v70, 0x3f803f80
    v_mov_b32 v71, 0x3f803f80
    s_add_u32 m0, s62, 16384
    s_xor_b32 s80, s51, 1
    s_lshl_b32 s63, s80, 7
    s_add_u32 s63, s63, s53
    buffer_load_dwordx4 v2, s[20:23], s63 offen offset:0 lds
    buffer_load_dwordx4 v3, s[20:23], s63 offen offset:1024 lds
    buffer_load_dwordx4 v4, s[20:23], s63 offen offset:2048 lds
    buffer_load_dwordx4 v5, s[20:23], s63 offen offset:3072 lds
    s_add_u32 m0, s62, 65536
    s_mul_i32 s64, s80, s89
    s_add_u32 s64, s64, s54
    buffer_load_dwordx4 v6, s[24:27], s64 offen offset:0 lds
    buffer_load_dwordx4 v7, s[24:27], s64 offen offset:1024 lds
    buffer_load_dwordx4 v8, s[24:27], s64 offen offset:2048 lds
    buffer_load_dwordx4 v9, s[24:27], s64 offen offset:3072 lds
    s_waitcnt lgkmcnt(0)
    s_add_u32 s59, s59, 2654435769
    v_mov_b32 v1, s59
    s_waitcnt vmcnt(8)
    s_barrier
    ds_read_b128 a[0:3], v144 offset:0
    ds_read_b64_tr_b16 v[32:33], v146 offset:0
    ds_read_b128 a[16:19], v145 offset:0
    ds_read_b64_tr_b16 v[34:35], v146 offset:1024
    ds_read_b128 a[4:7], v144 offset:2048
    ds_read_b64_tr_b16 v[36:37], v146 offset:8192
    ds_read_b128 a[20:23], v145 offset:2048
    ds_read_b64_tr_b16 v[38:39], v146 offset:9216
    ds_read_b128 a[8:11], v144 offset:4096
    ds_read_b128 a[24:27], v145 offset:4096
    ds_read_b128 a[12:15], v144 offset:6144
    ds_read_b128 a[28:31], v145 offset:6144
    s_add_u32 m0, s62, 32768
    s_xor_b32 s80, s51, 2
    s_lshl_b32 s63, s80, 7
    s_add_u32 s63, s63, s53
    buffer_load_dwordx4 v2, s[20:23], s63 offen offset:0 lds
    buffer_load_dwordx4 v3, s[20:23], s63 offen offset:1024 lds
    buffer_load_dwordx4 v4, s[20:23], s63 offen offset:2048 lds
    buffer_load_dwordx4 v5, s[20:23], s63 offen offset:3072 lds
    s_mul_i32 s64, s80, s89
    s_add_u32 s64, s64, s54
    s_waitcnt lgkmcnt(4)
    v_mfma_f32_16x16x32_bf16 v[160:163], a[0:3], v[32:35], 0
    ds_read_b64_tr_b16 v[40:41], v147 offset:0
    s_add_u32 m0, s62, 81920
    v_mfma_f32_16x16x32_bf16 v[160:163], a[16:19], v[36:39], v[160:163]
    ds_read_b64_tr_b16 v[42:43], v147 offset:1024
    buffer_load_dwordx4 v6, s[24:27], s64 offen offset:0 lds
    v_mfma_f32_16x16x32_bf16 v[168:171], a[20:23], v[36:39], 0
    ds_read_b64_tr_b16 v[44:45], v147 offset:8192
    s_xor_b32 s80, s51, 3
    v_mfma_f32_16x16x32_bf16 v[168:171], a[4:7], v[32:35], v[168:171]
    ds_read_b64_tr_b16 v[46:47], v147 offset:9216
    s_lshl_b32 s63, s80, 7
    s_waitcnt lgkmcnt(6)
    v_mfma_f32_16x16x32_bf16 v[176:179], a[8:11], v[32:35], 0
    ds_read_b64_tr_b16 v[48:49], v148 offset:0
    s_add_u32 s63, s63, s53
    v_mfma_f32_16x16x32_bf16 v[176:179], a[24:27], v[36:39], v[176:179]
    ds_read_b64_tr_b16 v[50:51], v148 offset:1024
    buffer_load_dwordx4 v7, s[24:27], s64 offen offset:1024 lds
    s_waitcnt lgkmcnt(6)
    v_mfma_f32_16x16x32_bf16 v[184:187], a[28:31], v[36:39], 0
    ds_read_b64_tr_b16 v[52:53], v148 offset:8192
    v_mfma_f32_16x16x32_bf16 v[184:187], a[12:15], v[32:35], v[184:187]
    ds_read_b64_tr_b16 v[54:55], v148 offset:9216
    s_waitcnt lgkmcnt(4)
    v_mfma_f32_16x16x32_bf16 v[188:191], a[12:15], v[40:43], 0
    ds_read_b64_tr_b16 v[56:57], v149 offset:0
    v_mfma_f32_16x16x32_bf16 v[188:191], a[28:31], v[44:47], v[188:191]
    ds_read_b64_tr_b16 v[58:59], v149 offset:1024
    buffer_load_dwordx4 v8, s[24:27], s64 offen offset:2048 lds
    v_mfma_f32_16x16x32_bf16 v[180:183], a[24:27], v[44:47], 0
    ds_read_b64_tr_b16 v[60:61], v149 offset:8192
    v_mfma_f32_16x16x32_bf16 v[180:183], a[8:11], v[40:43], v[180:183]
    ds_read_b64_tr_b16 v[62:63], v149 offset:9216
    v_mfma_f32_16x16x32_bf16 v[172:175], a[4:7], v[40:43], 0
    v_mfma_f32_16x16x32_bf16 v[172:175], a[20:23], v[44:47], v[172:175]
    buffer_load_dwordx4 v9, s[24:27], s64 offen offset:3072 lds
    v_mfma_f32_16x16x32_bf16 v[164:167], a[16:19], v[44:47], 0
    v_mfma_f32_16x16x32_bf16 v[164:167], a[0:3], v[40:43], v[164:167]
    s_waitcnt vmcnt(8) lgkmcnt(0)
    s_barrier
    v_mfma_f32_16x16x32_bf16 v[192:195], a[0:3], v[48:51], 0
    ds_read_b128 a[32:35], v144 offset:16384
    s_add_u32 m0, s62, 0
    v_mfma_f32_16x16x32_bf16 v[192:195], a[16:19], v[52:55], v[192:195]
    ds_read_b64_tr_b16 v[32:33], v146 offset:16384
    buffer_load_dwordx4 v2, s[20:23], s63 offen offset:0 lds
    v_mfma_f32_16x16x32_bf16 v[200:203], a[20:23], v[52:55], 0
    ds_read_b128 a[48:51], v145 offset:16384
    s_mul_i32 s64, s80, s89
    v_mfma_f32_16x16x32_bf16 v[200:203], a[4:7], v[48:51], v[200:203]
    ds_read_b64_tr_b16 v[34:35], v146 offset:17408
    s_add_u32 s64, s64, s54
    v_mfma_f32_16x16x32_bf16 v[208:211], a[8:11], v[48:51], 0
    ds_read_b128 a[36:39], v144 offset:18432
    v_mfma_f32_16x16x32_bf16 v[208:211], a[24:27], v[52:55], v[208:211]
    ds_read_b64_tr_b16 v[36:37], v146 offset:24576
    buffer_load_dwordx4 v3, s[20:23], s63 offen offset:1024 lds
    v_mfma_f32_16x16x32_bf16 v[216:219], a[28:31], v[52:55], 0
    ds_read_b128 a[52:55], v145 offset:18432
    v_mfma_f32_16x16x32_bf16 v[216:219], a[12:15], v[48:51], v[216:219]
    ds_read_b64_tr_b16 v[38:39], v146 offset:25600
    v_mfma_f32_16x16x32_bf16 v[220:223], a[12:15], v[56:59], 0
    ds_read_b128 a[40:43], v144 offset:20480
    v_mfma_f32_16x16x32_bf16 v[220:223], a[28:31], v[60:63], v[220:223]
    buffer_load_dwordx4 v4, s[20:23], s63 offen offset:2048 lds
    v_mfma_f32_16x16x32_bf16 v[212:215], a[24:27], v[60:63], 0
    ds_read_b128 a[56:59], v145 offset:20480
    v_mfma_f32_16x16x32_bf16 v[212:215], a[8:11], v[56:59], v[212:215]
    v_mfma_f32_16x16x32_bf16 v[204:207], a[4:7], v[56:59], 0
    ds_read_b128 a[44:47], v144 offset:22528
    v_mfma_f32_16x16x32_bf16 v[204:207], a[20:23], v[60:63], v[204:207]
    buffer_load_dwordx4 v5, s[20:23], s63 offen offset:3072 lds
    v_mfma_f32_16x16x32_bf16 v[196:199], a[16:19], v[60:63], 0
    ds_read_b128 a[60:63], v145 offset:22528
    v_mfma_f32_16x16x32_bf16 v[196:199], a[0:3], v[56:59], v[196:199]
    s_waitcnt lgkmcnt(4)
    v_mfma_f32_16x16x32_bf16 v[160:163], a[32:35], v[32:35], v[160:163]
    ds_read_b64_tr_b16 v[40:41], v147 offset:16384
    s_add_u32 m0, s62, 49152
    v_mfma_f32_16x16x32_bf16 v[160:163], a[48:51], v[36:39], v[160:163]
    ds_read_b64_tr_b16 v[42:43], v147 offset:17408
    buffer_load_dwordx4 v6, s[24:27], s64 offen offset:0 lds
    v_mfma_f32_16x16x32_bf16 v[168:171], a[52:55], v[36:39], v[168:171]
    ds_read_b64_tr_b16 v[44:45], v147 offset:24576
    s_xor_b32 s80, s51, 4
    v_mfma_f32_16x16x32_bf16 v[168:171], a[36:39], v[32:35], v[168:171]
    ds_read_b64_tr_b16 v[46:47], v147 offset:25600
    s_lshl_b32 s63, s80, 7
    s_waitcnt lgkmcnt(6)
    v_mfma_f32_16x16x32_bf16 v[176:179], a[40:43], v[32:35], v[176:179]
    ds_read_b64_tr_b16 v[48:49], v148 offset:16384
    s_add_u32 s63, s63, s53
    v_mfma_f32_16x16x32_bf16 v[176:179], a[56:59], v[36:39], v[176:179]
    ds_read_b64_tr_b16 v[50:51], v148 offset:17408
    buffer_load_dwordx4 v7, s[24:27], s64 offen offset:1024 lds
    s_waitcnt lgkmcnt(6)
    v_mfma_f32_16x16x32_bf16 v[184:187], a[60:63], v[36:39], v[184:187]
    ds_read_b64_tr_b16 v[52:53], v148 offset:24576
    v_mfma_f32_16x16x32_bf16 v[184:187], a[44:47], v[32:35], v[184:187]
    ds_read_b64_tr_b16 v[54:55], v148 offset:25600
    s_waitcnt lgkmcnt(4)
    v_mfma_f32_16x16x32_bf16 v[188:191], a[44:47], v[40:43], v[188:191]
    ds_read_b64_tr_b16 v[56:57], v149 offset:16384
    v_mfma_f32_16x16x32_bf16 v[188:191], a[60:63], v[44:47], v[188:191]
    ds_read_b64_tr_b16 v[58:59], v149 offset:17408
    buffer_load_dwordx4 v8, s[24:27], s64 offen offset:2048 lds
    v_mfma_f32_16x16x32_bf16 v[180:183], a[56:59], v[44:47], v[180:183]
    ds_read_b64_tr_b16 v[60:61], v149 offset:24576
    v_mfma_f32_16x16x32_bf16 v[180:183], a[40:43], v[40:43], v[180:183]
    ds_read_b64_tr_b16 v[62:63], v149 offset:25600
    v_mfma_f32_16x16x32_bf16 v[172:175], a[36:39], v[40:43], v[172:175]
    v_mfma_f32_16x16x32_bf16 v[172:175], a[52:55], v[44:47], v[172:175]
    buffer_load_dwordx4 v9, s[24:27], s64 offen offset:3072 lds
    v_mfma_f32_16x16x32_bf16 v[164:167], a[48:51], v[44:47], v[164:167]
    v_mfma_f32_16x16x32_bf16 v[164:167], a[32:35], v[40:43], v[164:167]
    s_waitcnt vmcnt(8) lgkmcnt(0)
    s_barrier
    v_mfma_f32_16x16x32_bf16 v[192:195], a[32:35], v[48:51], v[192:195]
    ds_read_b128 a[64:67], v144 offset:32768
    s_add_u32 m0, s62, 16384
    v_mfma_f32_16x16x32_bf16 v[192:195], a[48:51], v[52:55], v[192:195]
    ds_read_b64_tr_b16 v[32:33], v146 offset:32768
    buffer_load_dwordx4 v2, s[20:23], s63 offen offset:0 lds
    v_mfma_f32_16x16x32_bf16 v[200:203], a[52:55], v[52:55], v[200:203]
    ds_read_b128 a[80:83], v145 offset:32768
    s_mul_i32 s64, s80, s89
    v_mfma_f32_16x16x32_bf16 v[200:203], a[36:39], v[48:51], v[200:203]
    ds_read_b64_tr_b16 v[34:35], v146 offset:33792
    s_add_u32 s64, s64, s54
    v_mfma_f32_16x16x32_bf16 v[208:211], a[40:43], v[48:51], v[208:211]
    ds_read_b128 a[68:71], v144 offset:34816
    v_mfma_f32_16x16x32_bf16 v[208:211], a[56:59], v[52:55], v[208:211]
    ds_read_b64_tr_b16 v[36:37], v146 offset:40960
    buffer_load_dwordx4 v3, s[20:23], s63 offen offset:1024 lds
    v_mfma_f32_16x16x32_bf16 v[216:219], a[60:63], v[52:55], v[216:219]
    ds_read_b128 a[84:87], v145 offset:34816
    v_mfma_f32_16x16x32_bf16 v[216:219], a[44:47], v[48:51], v[216:219]
    ds_read_b64_tr_b16 v[38:39], v146 offset:41984
    v_mfma_f32_16x16x32_bf16 v[220:223], a[44:47], v[56:59], v[220:223]
    ds_read_b128 a[72:75], v144 offset:36864
    v_mfma_f32_16x16x32_bf16 v[220:223], a[60:63], v[60:63], v[220:223]
    buffer_load_dwordx4 v4, s[20:23], s63 offen offset:2048 lds
    v_mfma_f32_16x16x32_bf16 v[212:215], a[56:59], v[60:63], v[212:215]
    ds_read_b128 a[88:91], v145 offset:36864
    v_mfma_f32_16x16x32_bf16 v[212:215], a[40:43], v[56:59], v[212:215]
    v_mfma_f32_16x16x32_bf16 v[204:207], a[36:39], v[56:59], v[204:207]
    ds_read_b128 a[76:79], v144 offset:38912
    v_mfma_f32_16x16x32_bf16 v[204:207], a[52:55], v[60:63], v[204:207]
    buffer_load_dwordx4 v5, s[20:23], s63 offen offset:3072 lds
    v_mfma_f32_16x16x32_bf16 v[196:199], a[48:51], v[60:63], v[196:199]
    ds_read_b128 a[92:95], v145 offset:38912
    v_mfma_f32_16x16x32_bf16 v[196:199], a[32:35], v[56:59], v[196:199]
    s_waitcnt lgkmcnt(4)
    v_mfma_f32_16x16x32_bf16 v[160:163], a[64:67], v[32:35], v[160:163]
    ds_read_b64_tr_b16 v[40:41], v147 offset:32768
    s_add_u32 m0, s62, 65536
    v_mfma_f32_16x16x32_bf16 v[160:163], a[80:83], v[36:39], v[160:163]
    ds_read_b64_tr_b16 v[42:43], v147 offset:33792
    buffer_load_dwordx4 v6, s[24:27], s64 offen offset:0 lds
    v_mfma_f32_16x16x32_bf16 v[168:171], a[84:87], v[36:39], v[168:171]
    ds_read_b64_tr_b16 v[44:45], v147 offset:40960
    s_xor_b32 s80, s51, 5
    v_mfma_f32_16x16x32_bf16 v[168:171], a[68:71], v[32:35], v[168:171]
    ds_read_b64_tr_b16 v[46:47], v147 offset:41984
    s_lshl_b32 s63, s80, 7
    s_waitcnt lgkmcnt(6)
    v_mfma_f32_16x16x32_bf16 v[176:179], a[72:75], v[32:35], v[176:179]
    ds_read_b64_tr_b16 v[48:49], v148 offset:32768
    s_add_u32 s63, s63, s53
    v_mfma_f32_16x16x32_bf16 v[176:179], a[88:91], v[36:39], v[176:179]
    ds_read_b64_tr_b16 v[50:51], v148 offset:33792
    buffer_load_dwordx4 v7, s[24:27], s64 offen offset:1024 lds
    s_waitcnt lgkmcnt(6)
    v_mfma_f32_16x16x32_bf16 v[184:187], a[92:95], v[36:39], v[184:187]
    ds_read_b64_tr_b16 v[52:53], v148 offset:40960
    v_mfma_f32_16x16x32_bf16 v[184:187], a[76:79], v[32:35], v[184:187]
    ds_read_b64_tr_b16 v[54:55], v148 offset:41984
    s_waitcnt lgkmcnt(4)
    v_mfma_f32_16x16x32_bf16 v[188:191], a[76:79], v[40:43], v[188:191]
    ds_read_b64_tr_b16 v[56:57], v149 offset:32768
    v_mfma_f32_16x16x32_bf16 v[188:191], a[92:95], v[44:47], v[188:191]
    ds_read_b64_tr_b16 v[58:59], v149 offset:33792
    buffer_load_dwordx4 v8, s[24:27], s64 offen offset:2048 lds
    v_mfma_f32_16x16x32_bf16 v[180:183], a[88:91], v[44:47], v[180:183]
    ds_read_b64_tr_b16 v[60:61], v149 offset:40960
    v_mfma_f32_16x16x32_bf16 v[180:183], a[72:75], v[40:43], v[180:183]
    ds_read_b64_tr_b16 v[62:63], v149 offset:41984
    v_mfma_f32_16x16x32_bf16 v[172:175], a[68:71], v[40:43], v[172:175]
    v_mfma_f32_16x16x32_bf16 v[172:175], a[84:87], v[44:47], v[172:175]
    buffer_load_dwordx4 v9, s[24:27], s64 offen offset:3072 lds
    v_mfma_f32_16x16x32_bf16 v[164:167], a[80:83], v[44:47], v[164:167]
    v_mfma_f32_16x16x32_bf16 v[164:167], a[64:67], v[40:43], v[164:167]
    s_waitcnt vmcnt(8) lgkmcnt(0)
    s_barrier
    v_mfma_f32_16x16x32_bf16 v[192:195], a[64:67], v[48:51], v[192:195]
    ds_read_b128 a[96:99], v144 offset:0
    s_add_u32 m0, s62, 32768
    v_mfma_f32_16x16x32_bf16 v[192:195], a[80:83], v[52:55], v[192:195]
    ds_read_b64_tr_b16 v[32:33], v146 offset:0
    buffer_load_dwordx4 v2, s[20:23], s63 offen offset:0 lds
    v_mfma_f32_16x16x32_bf16 v[200:203], a[84:87], v[52:55], v[200:203]
    ds_read_b128 a[112:115], v145 offset:0
    s_mul_i32 s64, s80, s89
    v_mfma_f32_16x16x32_bf16 v[200:203], a[68:71], v[48:51], v[200:203]
    ds_read_b64_tr_b16 v[34:35], v146 offset:1024
    s_add_u32 s64, s64, s54
    v_mfma_f32_16x16x32_bf16 v[208:211], a[72:75], v[48:51], v[208:211]
    ds_read_b128 a[100:103], v144 offset:2048
    v_mfma_f32_16x16x32_bf16 v[208:211], a[88:91], v[52:55], v[208:211]
    ds_read_b64_tr_b16 v[36:37], v146 offset:8192
    buffer_load_dwordx4 v3, s[20:23], s63 offen offset:1024 lds
    v_mfma_f32_16x16x32_bf16 v[216:219], a[92:95], v[52:55], v[216:219]
    ds_read_b128 a[116:119], v145 offset:2048
    v_mfma_f32_16x16x32_bf16 v[216:219], a[76:79], v[48:51], v[216:219]
    ds_read_b64_tr_b16 v[38:39], v146 offset:9216
    v_mfma_f32_16x16x32_bf16 v[220:223], a[76:79], v[56:59], v[220:223]
    ds_read_b128 a[104:107], v144 offset:4096
    v_mfma_f32_16x16x32_bf16 v[220:223], a[92:95], v[60:63], v[220:223]
    buffer_load_dwordx4 v4, s[20:23], s63 offen offset:2048 lds
    v_mfma_f32_16x16x32_bf16 v[212:215], a[88:91], v[60:63], v[212:215]
    ds_read_b128 a[120:123], v145 offset:4096
    v_mfma_f32_16x16x32_bf16 v[212:215], a[72:75], v[56:59], v[212:215]
    v_mfma_f32_16x16x32_bf16 v[204:207], a[68:71], v[56:59], v[204:207]
    ds_read_b128 a[108:111], v144 offset:6144
    v_mfma_f32_16x16x32_bf16 v[204:207], a[84:87], v[60:63], v[204:207]
    buffer_load_dwordx4 v5, s[20:23], s63 offen offset:3072 lds
    v_mfma_f32_16x16x32_bf16 v[196:199], a[80:83], v[60:63], v[196:199]
    ds_read_b128 a[124:127], v145 offset:6144
    v_mfma_f32_16x16x32_bf16 v[196:199], a[64:67], v[56:59], v[196:199]
    s_waitcnt lgkmcnt(4)
    v_mfma_f32_16x16x32_bf16 v[160:163], a[96:99], v[32:35], v[160:163]
    ds_read_b64_tr_b16 v[40:41], v147 offset:0
    s_add_u32 m0, s62, 81920
    v_mfma_f32_16x16x32_bf16 v[160:163], a[112:115], v[36:39], v[160:163]
    ds_read_b64_tr_b16 v[42:43], v147 offset:1024
    buffer_load_dwordx4 v6, s[24:27], s64 offen offset:0 lds
    v_mfma_f32_16x16x32_bf16 v[168:171], a[116:119], v[36:39], v[168:171]
    ds_read_b64_tr_b16 v[44:45], v147 offset:8192
    s_xor_b32 s80, s51, 6
    v_mfma_f32_16x16x32_bf16 v[168:171], a[100:103], v[32:35], v[168:171]
    ds_read_b64_tr_b16 v[46:47], v147 offset:9216
    s_lshl_b32 s63, s80, 7
    s_waitcnt lgkmcnt(6)
    v_mfma_f32_16x16x32_bf16 v[176:179], a[104:107], v[32:35], v[176:179]
    ds_read_b64_tr_b16 v[48:49], v148 offset:0
    s_add_u32 s63, s63, s53
    v_mfma_f32_16x16x32_bf16 v[176:179], a[120:123], v[36:39], v[176:179]
    ds_read_b64_tr_b16 v[50:51], v148 offset:1024
    buffer_load_dwordx4 v7, s[24:27], s64 offen offset:1024 lds
    s_waitcnt lgkmcnt(6)
    v_mfma_f32_16x16x32_bf16 v[184:187], a[124:127], v[36:39], v[184:187]
    ds_read_b64_tr_b16 v[52:53], v148 offset:8192
    v_mfma_f32_16x16x32_bf16 v[184:187], a[108:111], v[32:35], v[184:187]
    ds_read_b64_tr_b16 v[54:55], v148 offset:9216
    s_waitcnt lgkmcnt(4)
    v_mfma_f32_16x16x32_bf16 v[188:191], a[108:111], v[40:43], v[188:191]
    ds_read_b64_tr_b16 v[56:57], v149 offset:0
    v_mfma_f32_16x16x32_bf16 v[188:191], a[124:127], v[44:47], v[188:191]
    ds_read_b64_tr_b16 v[58:59], v149 offset:1024
    buffer_load_dwordx4 v8, s[24:27], s64 offen offset:2048 lds
    v_mfma_f32_16x16x32_bf16 v[180:183], a[120:123], v[44:47], v[180:183]
    ds_read_b64_tr_b16 v[60:61], v149 offset:8192
    v_mfma_f32_16x16x32_bf16 v[180:183], a[104:107], v[40:43], v[180:183]
    ds_read_b64_tr_b16 v[62:63], v149 offset:9216
    v_mfma_f32_16x16x32_bf16 v[172:175], a[100:103], v[40:43], v[172:175]
    v_mfma_f32_16x16x32_bf16 v[172:175], a[116:119], v[44:47], v[172:175]
    buffer_load_dwordx4 v9, s[24:27], s64 offen offset:3072 lds
    v_mfma_f32_16x16x32_bf16 v[164:167], a[112:115], v[44:47], v[164:167]
    v_mfma_f32_16x16x32_bf16 v[164:167], a[96:99], v[40:43], v[164:167]
    s_waitcnt vmcnt(8) lgkmcnt(0)
    s_barrier
    v_mfma_f32_16x16x32_bf16 v[192:195], a[96:99], v[48:51], v[192:195]
    ds_read_b128 a[128:131], v144 offset:16384
    s_add_u32 m0, s62, 0
    v_mfma_f32_16x16x32_bf16 v[192:195], a[112:115], v[52:55], v[192:195]
    ds_read_b64_tr_b16 v[32:33], v146 offset:16384
    buffer_load_dwordx4 v2, s[20:23], s63 offen offset:0 lds
    v_mfma_f32_16x16x32_bf16 v[200:203], a[116:119], v[52:55], v[200:203]
    ds_read_b128 a[144:147], v145 offset:16384
    s_mul_i32 s64, s80, s89
    v_mfma_f32_16x16x32_bf16 v[200:203], a[100:103], v[48:51], v[200:203]
    ds_read_b64_tr_b16 v[34:35], v146 offset:17408
    s_add_u32 s64, s64, s54
    v_mfma_f32_16x16x32_bf16 v[208:211], a[104:107], v[48:51], v[208:211]
    ds_read_b128 a[132:135], v144 offset:18432
    v_mfma_f32_16x16x32_bf16 v[208:211], a[120:123], v[52:55], v[208:211]
    ds_read_b64_tr_b16 v[36:37], v146 offset:24576
    buffer_load_dwordx4 v3, s[20:23], s63 offen offset:1024 lds
    v_mfma_f32_16x16x32_bf16 v[216:219], a[124:127], v[52:55], v[216:219]
    ds_read_b128 a[148:151], v145 offset:18432
    v_mfma_f32_16x16x32_bf16 v[216:219], a[108:111], v[48:51], v[216:219]
    ds_read_b64_tr_b16 v[38:39], v146 offset:25600
    v_mfma_f32_16x16x32_bf16 v[220:223], a[108:111], v[56:59], v[220:223]
    ds_read_b128 a[136:139], v144 offset:20480
    v_mfma_f32_16x16x32_bf16 v[220:223], a[124:127], v[60:63], v[220:223]
    buffer_load_dwordx4 v4, s[20:23], s63 offen offset:2048 lds
    v_mfma_f32_16x16x32_bf16 v[212:215], a[120:123], v[60:63], v[212:215]
    ds_read_b128 a[152:155], v145 offset:20480
    v_mfma_f32_16x16x32_bf16 v[212:215], a[104:107], v[56:59], v[212:215]
    v_mfma_f32_16x16x32_bf16 v[204:207], a[100:103], v[56:59], v[204:207]
    ds_read_b128 a[140:143], v144 offset:22528
    v_mfma_f32_16x16x32_bf16 v[204:207], a[116:119], v[60:63], v[204:207]
    buffer_load_dwordx4 v5, s[20:23], s63 offen offset:3072 lds
    v_mfma_f32_16x16x32_bf16 v[196:199], a[112:115], v[60:63], v[196:199]
    ds_read_b128 a[156:159], v145 offset:22528
    v_mfma_f32_16x16x32_bf16 v[196:199], a[96:99], v[56:59], v[196:199]
    s_waitcnt lgkmcnt(4)
    v_mfma_f32_16x16x32_bf16 v[160:163], a[128:131], v[32:35], v[160:163]
    ds_read_b64_tr_b16 v[40:41], v147 offset:16384
    s_add_u32 m0, s62, 49152
    v_mfma_f32_16x16x32_bf16 v[160:163], a[144:147], v[36:39], v[160:163]
    ds_read_b64_tr_b16 v[42:43], v147 offset:17408
    buffer_load_dwordx4 v6, s[24:27], s64 offen offset:0 lds
    v_mfma_f32_16x16x32_bf16 v[168:171], a[148:151], v[36:39], v[168:171]
    ds_read_b64_tr_b16 v[44:45], v147 offset:24576
    s_xor_b32 s80, s51, 7
    v_mfma_f32_16x16x32_bf16 v[168:171], a[132:135], v[32:35], v[168:171]
    ds_read_b64_tr_b16 v[46:47], v147 offset:25600
    s_lshl_b32 s63, s80, 7
    s_waitcnt lgkmcnt(6)
    v_mfma_f32_16x16x32_bf16 v[176:179], a[136:139], v[32:35], v[176:179]
    ds_read_b64_tr_b16 v[48:49], v148 offset:16384
    s_add_u32 s63, s63, s53
    v_mfma_f32_16x16x32_bf16 v[176:179], a[152:155], v[36:39], v[176:179]
    ds_read_b64_tr_b16 v[50:51], v148 offset:17408
    buffer_load_dwordx4 v7, s[24:27], s64 offen offset:1024 lds
    s_waitcnt lgkmcnt(6)
    v_mfma_f32_16x16x32_bf16 v[184:187], a[156:159], v[36:39], v[184:187]
    ds_read_b64_tr_b16 v[52:53], v148 offset:24576
    v_mfma_f32_16x16x32_bf16 v[184:187], a[140:143], v[32:35], v[184:187]
    ds_read_b64_tr_b16 v[54:55], v148 offset:25600
    s_waitcnt lgkmcnt(4)
    v_mfma_f32_16x16x32_bf16 v[188:191], a[140:143], v[40:43], v[188:191]
    ds_read_b64_tr_b16 v[56:57], v149 offset:16384
    v_mfma_f32_16x16x32_bf16 v[188:191], a[156:159], v[44:47], v[188:191]
    ds_read_b64_tr_b16 v[58:59], v149 offset:17408
    buffer_load_dwordx4 v8, s[24:27], s64 offen offset:2048 lds
    v_mfma_f32_16x16x32_bf16 v[180:183], a[152:155], v[44:47], v[180:183]
    ds_read_b64_tr_b16 v[60:61], v149 offset:24576
    v_mfma_f32_16x16x32_bf16 v[180:183], a[136:139], v[40:43], v[180:183]
    ds_read_b64_tr_b16 v[62:63], v149 offset:25600
    v_mfma_f32_16x16x32_bf16 v[172:175], a[132:135], v[40:43], v[172:175]
    v_mfma_f32_16x16x32_bf16 v[172:175], a[148:151], v[44:47], v[172:175]
    buffer_load_dwordx4 v9, s[24:27], s64 offen offset:3072 lds
    v_mfma_f32_16x16x32_bf16 v[164:167], a[144:147], v[44:47], v[164:167]
    v_mfma_f32_16x16x32_bf16 v[164:167], a[128:131], v[40:43], v[164:167]
    s_waitcnt vmcnt(8) lgkmcnt(0)
    s_barrier
    v_mfma_f32_16x16x32_bf16 v[192:195], a[128:131], v[48:51], v[192:195]
    ds_read_b128 a[160:163], v144 offset:32768
    s_add_u32 m0, s62, 16384
    v_mfma_f32_16x16x32_bf16 v[192:195], a[144:147], v[52:55], v[192:195]
    ds_read_b64_tr_b16 v[32:33], v146 offset:32768
    buffer_load_dwordx4 v2, s[20:23], s63 offen offset:0 lds
    v_mfma_f32_16x16x32_bf16 v[200:203], a[148:151], v[52:55], v[200:203]
    ds_read_b128 a[176:179], v145 offset:32768
    s_mul_i32 s64, s80, s89
    v_mfma_f32_16x16x32_bf16 v[200:203], a[132:135], v[48:51], v[200:203]
    ds_read_b64_tr_b16 v[34:35], v146 offset:33792
    s_add_u32 s64, s64, s54
    v_mfma_f32_16x16x32_bf16 v[208:211], a[136:139], v[48:51], v[208:211]
    ds_read_b128 a[164:167], v144 offset:34816
    v_mfma_f32_16x16x32_bf16 v[208:211], a[152:155], v[52:55], v[208:211]
    ds_read_b64_tr_b16 v[36:37], v146 offset:40960
    buffer_load_dwordx4 v3, s[20:23], s63 offen offset:1024 lds
    v_mfma_f32_16x16x32_bf16 v[216:219], a[156:159], v[52:55], v[216:219]
    ds_read_b128 a[180:183], v145 offset:34816
    v_mfma_f32_16x16x32_bf16 v[216:219], a[140:143], v[48:51], v[216:219]
    ds_read_b64_tr_b16 v[38:39], v146 offset:41984
    v_mfma_f32_16x16x32_bf16 v[220:223], a[140:143], v[56:59], v[220:223]
    ds_read_b128 a[168:171], v144 offset:36864
    v_mfma_f32_16x16x32_bf16 v[220:223], a[156:159], v[60:63], v[220:223]
    buffer_load_dwordx4 v4, s[20:23], s63 offen offset:2048 lds
    v_mfma_f32_16x16x32_bf16 v[212:215], a[152:155], v[60:63], v[212:215]
    ds_read_b128 a[184:187], v145 offset:36864
    v_mfma_f32_16x16x32_bf16 v[212:215], a[136:139], v[56:59], v[212:215]
    v_mfma_f32_16x16x32_bf16 v[204:207], a[132:135], v[56:59], v[204:207]
    ds_read_b128 a[172:175], v144 offset:38912
    v_mfma_f32_16x16x32_bf16 v[204:207], a[148:151], v[60:63], v[204:207]
    buffer_load_dwordx4 v5, s[20:23], s63 offen offset:3072 lds
    v_mfma_f32_16x16x32_bf16 v[196:199], a[144:147], v[60:63], v[196:199]
    ds_read_b128 a[188:191], v145 offset:38912
    v_mfma_f32_16x16x32_bf16 v[196:199], a[128:131], v[56:59], v[196:199]
    s_waitcnt lgkmcnt(4)
    v_mfma_f32_16x16x32_bf16 v[160:163], a[160:163], v[32:35], v[160:163]
    ds_read_b64_tr_b16 v[40:41], v147 offset:32768
    s_add_u32 m0, s62, 65536
    v_mfma_f32_16x16x32_bf16 v[160:163], a[176:179], v[36:39], v[160:163]
    ds_read_b64_tr_b16 v[42:43], v147 offset:33792
    buffer_load_dwordx4 v6, s[24:27], s64 offen offset:0 lds
    v_mfma_f32_16x16x32_bf16 v[168:171], a[180:183], v[36:39], v[168:171]
    ds_read_b64_tr_b16 v[44:45], v147 offset:40960
    s_xor_b32 s80, s51, 0
    v_mfma_f32_16x16x32_bf16 v[168:171], a[164:167], v[32:35], v[168:171]
    ds_read_b64_tr_b16 v[46:47], v147 offset:41984
    s_mul_i32 s63, s80, s4
    s_waitcnt lgkmcnt(6)
    v_mfma_f32_16x16x32_bf16 v[176:179], a[168:171], v[32:35], v[176:179]
    ds_read_b64_tr_b16 v[48:49], v148 offset:32768
    s_add_u32 s63, s63, s61
    v_mfma_f32_16x16x32_bf16 v[176:179], a[184:187], v[36:39], v[176:179]
    ds_read_b64_tr_b16 v[50:51], v148 offset:33792
    buffer_load_dwordx4 v7, s[24:27], s64 offen offset:1024 lds
    s_waitcnt lgkmcnt(6)
    v_mfma_f32_16x16x32_bf16 v[184:187], a[188:191], v[36:39], v[184:187]
    ds_read_b64_tr_b16 v[52:53], v148 offset:40960
    s_add_u32 s14, s63, s9
    v_mfma_f32_16x16x32_bf16 v[184:187], a[172:175], v[32:35], v[184:187]
    ds_read_b64_tr_b16 v[54:55], v148 offset:41984
    s_waitcnt lgkmcnt(4)
    v_mfma_f32_16x16x32_bf16 v[188:191], a[172:175], v[40:43], v[188:191]
    ds_read_b64_tr_b16 v[56:57], v149 offset:32768
    v_mfma_f32_16x16x32_bf16 v[188:191], a[188:191], v[44:47], v[188:191]
    ds_read_b64_tr_b16 v[58:59], v149 offset:33792
    buffer_load_dwordx4 v8, s[24:27], s64 offen offset:2048 lds
    v_mfma_f32_16x16x32_bf16 v[180:183], a[184:187], v[44:47], v[180:183]
    ds_read_b64_tr_b16 v[60:61], v149 offset:40960
    v_mfma_f32_16x16x32_bf16 v[180:183], a[168:171], v[40:43], v[180:183]
    ds_read_b64_tr_b16 v[62:63], v149 offset:41984
    v_mfma_f32_16x16x32_bf16 v[172:175], a[164:167], v[40:43], v[172:175]
    v_mfma_f32_16x16x32_bf16 v[172:175], a[180:183], v[44:47], v[172:175]
    buffer_load_dwordx4 v9, s[24:27], s64 offen offset:3072 lds
    v_mfma_f32_16x16x32_bf16 v[164:167], a[176:179], v[44:47], v[164:167]
    v_mfma_f32_16x16x32_bf16 v[164:167], a[160:163], v[40:43], v[164:167]
    s_waitcnt vmcnt(8) lgkmcnt(0)
    s_barrier
    v_mfma_f32_16x16x32_bf16 v[192:195], a[160:163], v[48:51], v[192:195]
    ds_read_b128 a[192:195], v144 offset:0
    s_add_u32 m0, s60, 98304
    v_mfma_f32_16x16x32_bf16 v[192:195], a[176:179], v[52:55], v[192:195]
    ds_read_b64_tr_b16 v[32:33], v146 offset:0
    buffer_load_dwordx4 v10, s[44:47], s63 offen lds
    v_mfma_f32_16x16x32_bf16 v[200:203], a[180:183], v[52:55], v[200:203]
    ds_read_b128 a[208:211], v145 offset:0
    s_xor_b32 s80, s51, 2
    v_mfma_f32_16x16x32_bf16 v[200:203], a[164:167], v[48:51], v[200:203]
    ds_read_b64_tr_b16 v[34:35], v146 offset:1024
    s_mul_i32 s64, s80, s4
    v_mfma_f32_16x16x32_bf16 v[208:211], a[168:171], v[48:51], v[208:211]
    ds_read_b128 a[196:199], v144 offset:2048
    s_add_u32 m0, s60, 99328
    v_mfma_f32_16x16x32_bf16 v[208:211], a[184:187], v[52:55], v[208:211]
    ds_read_b64_tr_b16 v[36:37], v146 offset:8192
    buffer_load_dwordx4 v11, s[44:47], s63 offen lds
    v_mfma_f32_16x16x32_bf16 v[216:219], a[188:191], v[52:55], v[216:219]
    ds_read_b128 a[212:215], v145 offset:2048
    s_add_u32 s64, s64, s61
    v_mfma_f32_16x16x32_bf16 v[216:219], a[172:175], v[48:51], v[216:219]
    ds_read_b64_tr_b16 v[38:39], v146 offset:9216
    s_add_u32 s15, s64, s9
    v_mfma_f32_16x16x32_bf16 v[220:223], a[172:175], v[56:59], v[220:223]
    ds_read_b128 a[200:203], v144 offset:4096
    s_add_u32 m0, s60, 106496
    v_mfma_f32_16x16x32_bf16 v[220:223], a[188:191], v[60:63], v[220:223]
    buffer_load_dwordx4 v10, s[44:47], s14 offen lds
    v_mfma_f32_16x16x32_bf16 v[212:215], a[184:187], v[60:63], v[212:215]
    ds_read_b128 a[216:219], v145 offset:4096
    v_mfma_f32_16x16x32_bf16 v[212:215], a[168:171], v[56:59], v[212:215]
    v_mfma_f32_16x16x32_bf16 v[204:207], a[164:167], v[56:59], v[204:207]
    ds_read_b128 a[204:207], v144 offset:6144
    s_add_u32 m0, s60, 107520
    v_mfma_f32_16x16x32_bf16 v[204:207], a[180:183], v[60:63], v[204:207]
    buffer_load_dwordx4 v11, s[44:47], s14 offen lds
    v_mfma_f32_16x16x32_bf16 v[196:199], a[176:179], v[60:63], v[196:199]
    ds_read_b128 a[220:223], v145 offset:6144
    v_mfma_f32_16x16x32_bf16 v[196:199], a[160:163], v[56:59], v[196:199]
    s_waitcnt lgkmcnt(4)
    v_mfma_f32_16x16x32_bf16 v[160:163], a[192:195], v[32:35], v[160:163]
    ds_read_b64_tr_b16 v[40:41], v147 offset:0
    s_add_u32 m0, s60, 114688
    v_mfma_f32_16x16x32_bf16 v[160:163], a[208:211], v[36:39], v[160:163]
    ds_read_b64_tr_b16 v[42:43], v147 offset:1024
    buffer_load_dwordx4 v10, s[44:47], s64 offen lds
    v_mfma_f32_16x16x32_bf16 v[168:171], a[212:215], v[36:39], v[168:171]
    ds_read_b64_tr_b16 v[44:45], v147 offset:8192
    s_xor_b32 s80, s51, 4
    v_mfma_f32_16x16x32_bf16 v[168:171], a[196:199], v[32:35], v[168:171]
    ds_read_b64_tr_b16 v[46:47], v147 offset:9216
    s_mul_i32 s63, s80, s4
    s_waitcnt lgkmcnt(6)
    v_mfma_f32_16x16x32_bf16 v[176:179], a[200:203], v[32:35], v[176:179]
    ds_read_b64_tr_b16 v[48:49], v148 offset:0
    s_add_u32 m0, s60, 115712
    v_mfma_f32_16x16x32_bf16 v[176:179], a[216:219], v[36:39], v[176:179]
    ds_read_b64_tr_b16 v[50:51], v148 offset:1024
    buffer_load_dwordx4 v11, s[44:47], s64 offen lds
    s_waitcnt lgkmcnt(6)
    v_mfma_f32_16x16x32_bf16 v[184:187], a[220:223], v[36:39], v[184:187]
    ds_read_b64_tr_b16 v[52:53], v148 offset:8192
    s_add_u32 s63, s63, s61
    v_mfma_f32_16x16x32_bf16 v[184:187], a[204:207], v[32:35], v[184:187]
    ds_read_b64_tr_b16 v[54:55], v148 offset:9216
    s_add_u32 s14, s63, s9
    s_waitcnt lgkmcnt(4)
    v_mfma_f32_16x16x32_bf16 v[188:191], a[204:207], v[40:43], v[188:191]
    ds_read_b64_tr_b16 v[56:57], v149 offset:0
    s_add_u32 m0, s60, 122880
    v_mfma_f32_16x16x32_bf16 v[188:191], a[220:223], v[44:47], v[188:191]
    ds_read_b64_tr_b16 v[58:59], v149 offset:1024
    buffer_load_dwordx4 v10, s[44:47], s15 offen lds
    v_mfma_f32_16x16x32_bf16 v[180:183], a[216:219], v[44:47], v[180:183]
    ds_read_b64_tr_b16 v[60:61], v149 offset:8192
    v_mfma_f32_16x16x32_bf16 v[180:183], a[200:203], v[40:43], v[180:183]
    ds_read_b64_tr_b16 v[62:63], v149 offset:9216
    v_mfma_f32_16x16x32_bf16 v[172:175], a[196:199], v[40:43], v[172:175]
    s_add_u32 m0, s60, 123904
    v_mfma_f32_16x16x32_bf16 v[172:175], a[212:215], v[44:47], v[172:175]
    buffer_load_dwordx4 v11, s[44:47], s15 offen lds
    v_mfma_f32_16x16x32_bf16 v[164:167], a[208:211], v[44:47], v[164:167]
    v_mfma_f32_16x16x32_bf16 v[164:167], a[192:195], v[40:43], v[164:167]
    s_waitcnt vmcnt(8) lgkmcnt(0)
    s_barrier
    v_mfma_f32_16x16x32_bf16 v[192:195], a[192:195], v[48:51], v[192:195]
    ds_read_b128 a[224:227], v144 offset:16384
    s_add_u32 m0, s60, 131072
    v_mfma_f32_16x16x32_bf16 v[192:195], a[208:211], v[52:55], v[192:195]
    ds_read_b64_tr_b16 v[32:33], v146 offset:16384
    buffer_load_dwordx4 v10, s[44:47], s63 offen lds
    v_mfma_f32_16x16x32_bf16 v[200:203], a[212:215], v[52:55], v[200:203]
    ds_read_b128 a[240:243], v145 offset:16384
    s_xor_b32 s80, s51, 6
    v_mfma_f32_16x16x32_bf16 v[200:203], a[196:199], v[48:51], v[200:203]
    ds_read_b64_tr_b16 v[34:35], v146 offset:17408
    s_mul_i32 s64, s80, s4
    v_mfma_f32_16x16x32_bf16 v[208:211], a[200:203], v[48:51], v[208:211]
    ds_read_b128 a[228:231], v144 offset:18432
    s_add_u32 m0, s60, 132096
    v_mfma_f32_16x16x32_bf16 v[208:211], a[216:219], v[52:55], v[208:211]
    ds_read_b64_tr_b16 v[36:37], v146 offset:24576
    buffer_load_dwordx4 v11, s[44:47], s63 offen lds
    v_mfma_f32_16x16x32_bf16 v[216:219], a[220:223], v[52:55], v[216:219]
    ds_read_b128 a[244:247], v145 offset:18432
    s_add_u32 s64, s64, s61
    v_mfma_f32_16x16x32_bf16 v[216:219], a[204:207], v[48:51], v[216:219]
    ds_read_b64_tr_b16 v[38:39], v146 offset:25600
    s_add_u32 s15, s64, s9
    v_mfma_f32_16x16x32_bf16 v[220:223], a[204:207], v[56:59], v[220:223]
    ds_read_b128 a[232:235], v144 offset:20480
    s_add_u32 m0, s60, 139264
    v_mfma_f32_16x16x32_bf16 v[220:223], a[220:223], v[60:63], v[220:223]
    buffer_load_dwordx4 v10, s[44:47], s14 offen lds
    v_mfma_f32_16x16x32_bf16 v[212:215], a[216:219], v[60:63], v[212:215]
    ds_read_b128 a[248:251], v145 offset:20480
    v_mfma_f32_16x16x32_bf16 v[212:215], a[200:203], v[56:59], v[212:215]
    v_mfma_f32_16x16x32_bf16 v[204:207], a[196:199], v[56:59], v[204:207]
    ds_read_b128 a[236:239], v144 offset:22528
    s_add_u32 m0, s60, 140288
    v_mfma_f32_16x16x32_bf16 v[204:207], a[212:215], v[60:63], v[204:207]
    buffer_load_dwordx4 v11, s[44:47], s14 offen lds
    v_mfma_f32_16x16x32_bf16 v[196:199], a[208:211], v[60:63], v[196:199]
    ds_read_b128 a[252:255], v145 offset:22528
    v_mfma_f32_16x16x32_bf16 v[196:199], a[192:195], v[56:59], v[196:199]
    s_waitcnt lgkmcnt(4)
    v_mfma_f32_16x16x32_bf16 v[160:163], a[224:227], v[32:35], v[160:163]
    ds_read_b64_tr_b16 v[40:41], v147 offset:16384
    s_add_u32 m0, s60, 147456
    v_mfma_f32_16x16x32_bf16 v[160:163], a[240:243], v[36:39], v[160:163]
    ds_read_b64_tr_b16 v[42:43], v147 offset:17408
    buffer_load_dwordx4 v10, s[44:47], s64 offen lds
    v_mfma_f32_16x16x32_bf16 v[168:171], a[244:247], v[36:39], v[168:171]
    ds_read_b64_tr_b16 v[44:45], v147 offset:24576
    v_mfma_f32_16x16x32_bf16 v[168:171], a[228:231], v[32:35], v[168:171]
    ds_read_b64_tr_b16 v[46:47], v147 offset:25600
    s_waitcnt lgkmcnt(6)
    v_mfma_f32_16x16x32_bf16 v[176:179], a[232:235], v[32:35], v[176:179]
    ds_read_b64_tr_b16 v[48:49], v148 offset:16384
    s_add_u32 m0, s60, 148480
    v_mfma_f32_16x16x32_bf16 v[176:179], a[248:251], v[36:39], v[176:179]
    ds_read_b64_tr_b16 v[50:51], v148 offset:17408
    buffer_load_dwordx4 v11, s[44:47], s64 offen lds
    s_waitcnt lgkmcnt(6)
    v_mfma_f32_16x16x32_bf16 v[184:187], a[252:255], v[36:39], v[184:187]
    ds_read_b64_tr_b16 v[52:53], v148 offset:24576
    v_mfma_f32_16x16x32_bf16 v[184:187], a[236:239], v[32:35], v[184:187]
    ds_read_b64_tr_b16 v[54:55], v148 offset:25600
    s_waitcnt lgkmcnt(4)
    v_mfma_f32_16x16x32_bf16 v[188:191], a[236:239], v[40:43], v[188:191]
    ds_read_b64_tr_b16 v[56:57], v149 offset:16384
    s_add_u32 m0, s60, 155648
    v_mfma_f32_16x16x32_bf16 v[188:191], a[252:255], v[44:47], v[188:191]
    ds_read_b64_tr_b16 v[58:59], v149 offset:17408
    buffer_load_dwordx4 v10, s[44:47], s15 offen lds
    v_mfma_f32_16x16x32_bf16 v[180:183], a[248:251], v[44:47], v[180:183]
    ds_read_b64_tr_b16 v[60:61], v149 offset:24576
    v_mfma_f32_16x16x32_bf16 v[180:183], a[232:235], v[40:43], v[180:183]
    ds_read_b64_tr_b16 v[62:63], v149 offset:25600
    v_mfma_f32_16x16x32_bf16 v[172:175], a[228:231], v[40:43], v[172:175]
    s_add_u32 m0, s60, 156672
    v_mfma_f32_16x16x32_bf16 v[172:175], a[244:247], v[44:47], v[172:175]
    buffer_load_dwordx4 v11, s[44:47], s15 offen lds
    v_mfma_f32_16x16x32_bf16 v[164:167], a[240:243], v[44:47], v[164:167]
    v_mfma_f32_16x16x32_bf16 v[164:167], a[224:227], v[40:43], v[164:167]
    s_waitcnt vmcnt(8) lgkmcnt(0)
    s_barrier
    v_mfma_f32_16x16x32_bf16 v[192:195], a[224:227], v[48:51], v[192:195]
    ds_read_b64_tr_b16 v[32:33], v150 offset:0
    v_mfma_f32_16x16x32_bf16 v[192:195], a[240:243], v[52:55], v[192:195]
    ds_read_b64_tr_b16 v[34:35], v150 offset:512
    v_mfma_f32_16x16x32_bf16 v[200:203], a[244:247], v[52:55], v[200:203]
    ds_read_b64_tr_b16 v[36:37], v150 offset:4096
    v_mfma_f32_16x16x32_bf16 v[200:203], a[228:231], v[48:51], v[200:203]
    ds_read_b64_tr_b16 v[38:39], v150 offset:4608
    v_mfma_f32_16x16x32_bf16 v[208:211], a[232:235], v[48:51], v[208:211]
    ds_read_b64_tr_b16 v[40:41], v151 offset:0
    v_mfma_f32_16x16x32_bf16 v[208:211], a[248:251], v[52:55], v[208:211]
    ds_read_b64_tr_b16 v[42:43], v151 offset:512
    v_mfma_f32_16x16x32_bf16 v[216:219], a[252:255], v[52:55], v[216:219]
    ds_read_b64_tr_b16 v[44:45], v151 offset:4096
    v_mfma_f32_16x16x32_bf16 v[216:219], a[236:239], v[48:51], v[216:219]
    ds_read_b64_tr_b16 v[46:47], v151 offset:4608
    v_mfma_f32_16x16x32_bf16 v[220:223], a[236:239], v[56:59], v[220:223]
    v_mfma_f32_16x16x32_bf16 v[220:223], a[252:255], v[60:63], v[220:223]
    v_mfma_f32_16x16x32_bf16 v[212:215], a[248:251], v[60:63], v[212:215]
    v_mfma_f32_16x16x32_bf16 v[212:215], a[232:235], v[56:59], v[212:215]
    v_mfma_f32_16x16x32_bf16 v[204:207], a[228:231], v[56:59], v[204:207]
    v_mfma_f32_16x16x32_bf16 v[204:207], a[244:247], v[60:63], v[204:207]
    v_mfma_f32_16x16x32_bf16 v[196:199], a[240:243], v[60:63], v[196:199]
    v_mfma_f32_16x16x32_bf16 v[196:199], a[224:227], v[56:59], v[196:199]
    s_waitcnt lgkmcnt(4)
    v_mfma_f32_16x16x32_bf16 v[224:227], v[32:35], a[0:3], 0
    ds_read_b64_tr_b16 v[48:49], v150 offset:8192
    v_mfma_f32_16x16x32_bf16 v[224:227], v[36:39], a[16:19], v[224:227]
    v_mfma_f32_16x16x32_bf16 v[232:235], v[36:39], a[20:23], 0
    ds_read_b64_tr_b16 v[50:51], v150 offset:8704
    v_pk_mul_f32 v[64:65], v[160:161], s[90:91] op_sel_hi:[1,0]
    v_mfma_f32_16x16x32_bf16 v[232:235], v[32:35], a[4:7], v[232:235]
    v_pk_mul_f32 v[66:67], v[162:163], s[90:91] op_sel_hi:[1,0]
    v_exp_f32_e64 v64, v64 clamp
    v_exp_f32_e64 v65, v65 clamp
    s_add_u32 m0, s12, 0
    s_add_u32 s64, s71, 0
    buffer_load_dwordx4 v12, s[28:31], s64 offen offset:0 lds
    v_exp_f32_e64 v66, v66 clamp
    v_exp_f32_e64 v67, v67 clamp
    v_max_f32 v160, s91, v160
    v_max_f32 v161, s91, v161
    v_max_f32 v162, s91, v162
    v_max_f32 v163, s91, v163
    v_pk_add_f32 v[160:161], v[160:161], v[64:65]
    v_pk_add_f32 v[162:163], v[162:163], v[66:67]
    buffer_load_dwordx4 v13, s[28:31], s64 offen offset:1024 lds
    v_cvt_pk_bf16_f32 v72, v160, v161
    v_cvt_pk_bf16_f32 v73, v162, v163
    v_pk_mul_f32 v[64:65], v[164:165], s[90:91] op_sel_hi:[1,0]
    v_pk_mul_f32 v[66:67], v[166:167], s[90:91] op_sel_hi:[1,0]
    v_exp_f32_e64 v64, v64 clamp
    v_exp_f32_e64 v65, v65 clamp
    v_exp_f32_e64 v66, v66 clamp
    v_exp_f32_e64 v67, v67 clamp
    buffer_load_dwordx4 v14, s[28:31], s64 offen offset:2048 lds
    v_max_f32 v164, s91, v164
    v_max_f32 v165, s91, v165
    v_max_f32 v166, s91, v166
    v_max_f32 v167, s91, v167
    v_pk_add_f32 v[164:165], v[164:165], v[64:65]
    v_pk_add_f32 v[166:167], v[166:167], v[66:67]
    v_cvt_pk_bf16_f32 v76, v164, v165
    v_cvt_pk_bf16_f32 v77, v166, v167
    buffer_load_dwordx4 v15, s[28:31], s64 offen offset:3072 lds
    v_pk_mul_f32 v[64:65], v[168:169], s[90:91] op_sel_hi:[1,0]
    v_pk_mul_f32 v[66:67], v[170:171], s[90:91] op_sel_hi:[1,0]
    v_exp_f32_e64 v64, v64 clamp
    v_exp_f32_e64 v65, v65 clamp
    v_exp_f32_e64 v66, v66 clamp
    v_exp_f32_e64 v67, v67 clamp
    v_max_f32 v168, s91, v168
    v_max_f32 v169, s91, v169
    s_add_u32 m0, s12, 4096
    s_add_u32 s64, s71, 196608
    buffer_load_dwordx4 v12, s[28:31], s64 offen offset:0 lds
    v_max_f32 v170, s91, v170
    v_max_f32 v171, s91, v171
    v_pk_add_f32 v[168:169], v[168:169], v[64:65]
    v_pk_add_f32 v[170:171], v[170:171], v[66:67]
    v_cvt_pk_bf16_f32 v74, v168, v169
    v_cvt_pk_bf16_f32 v75, v170, v171
    v_pk_mul_f32 v[64:65], v[172:173], s[90:91] op_sel_hi:[1,0]
    v_pk_mul_f32 v[66:67], v[174:175], s[90:91] op_sel_hi:[1,0]
    buffer_load_dwordx4 v13, s[28:31], s64 offen offset:1024 lds
    v_exp_f32_e64 v64, v64 clamp
    v_exp_f32_e64 v65, v65 clamp
    v_exp_f32_e64 v66, v66 clamp
    v_exp_f32_e64 v67, v67 clamp
    v_max_f32 v172, s91, v172
    v_max_f32 v173, s91, v173
    v_max_f32 v174, s91, v174
    v_max_f32 v175, s91, v175
    buffer_load_dwordx4 v14, s[28:31], s64 offen offset:2048 lds
    v_pk_add_f32 v[172:173], v[172:173], v[64:65]
    v_pk_add_f32 v[174:175], v[174:175], v[66:67]
    v_cvt_pk_bf16_f32 v78, v172, v173
    v_cvt_pk_bf16_f32 v79, v174, v175
    v_cvt_pk_bf16_f32 v112, v192, v193
    v_cvt_pk_bf16_f32 v113, v194, v195
    v_cvt_pk_bf16_f32 v116, v196, v197
    v_cvt_pk_bf16_f32 v117, v198, v199
    buffer_load_dwordx4 v15, s[28:31], s64 offen offset:3072 lds
    v_cvt_pk_bf16_f32 v114, v200, v201
    v_cvt_pk_bf16_f32 v115, v202, v203
    v_cvt_pk_bf16_f32 v118, v204, v205
    v_cvt_pk_bf16_f32 v119, v206, v207
    s_nop 0
    v_pk_mul_f32 v[64:65], v[176:177], s[90:91] op_sel_hi:[1,0]
    v_pk_mul_f32 v[66:67], v[178:179], s[90:91] op_sel_hi:[1,0]
    v_exp_f32_e64 v64, v64 clamp
    v_exp_f32_e64 v65, v65 clamp
    v_exp_f32_e64 v66, v66 clamp
    v_exp_f32_e64 v67, v67 clamp
    v_max_f32 v176, s91, v176
    v_max_f32 v177, s91, v177
    s_add_u32 m0, s12, 8192
    s_add_u32 s64, s71, 360448
    buffer_load_dwordx4 v12, s[28:31], s64 offen offset:0 lds
    v_max_f32 v178, s91, v178
    v_max_f32 v179, s91, v179
    v_pk_add_f32 v[176:177], v[176:177], v[64:65]
    v_pk_add_f32 v[178:179], v[178:179], v[66:67]
    v_cvt_pk_bf16_f32 v80, v176, v177
    v_mfma_f32_16x16x32_bf16 v[136:139], v[68:71], v[72:75], 0
    v_cvt_pk_bf16_f32 v81, v178, v179
    v_pk_mul_f32 v[64:65], v[180:181], s[90:91] op_sel_hi:[1,0]
    v_pk_mul_f32 v[66:67], v[182:183], s[90:91] op_sel_hi:[1,0]
    v_exp_f32_e64 v64, v64 clamp
    v_exp_f32_e64 v65, v65 clamp
    v_exp_f32_e64 v66, v66 clamp
    v_exp_f32_e64 v67, v67 clamp
    v_max_f32 v180, s91, v180
    v_max_f32 v181, s91, v181
    v_max_f32 v182, s91, v182
    v_max_f32 v183, s91, v183
    buffer_load_dwordx4 v13, s[28:31], s64 offen offset:1024 lds
    v_pk_add_f32 v[180:181], v[180:181], v[64:65]
    v_pk_add_f32 v[182:183], v[182:183], v[66:67]
    v_mfma_f32_16x16x32_bf16 v[140:143], v[68:71], v[76:79], 0
    v_cvt_pk_bf16_f32 v84, v180, v181
    v_cvt_pk_bf16_f32 v85, v182, v183
    v_pk_mul_f32 v[64:65], v[184:185], s[90:91] op_sel_hi:[1,0]
    v_pk_mul_f32 v[66:67], v[186:187], s[90:91] op_sel_hi:[1,0]
    v_exp_f32_e64 v64, v64 clamp
    v_exp_f32_e64 v65, v65 clamp
    v_exp_f32_e64 v66, v66 clamp
    v_exp_f32_e64 v67, v67 clamp
    v_max_f32 v184, s91, v184
    v_max_f32 v185, s91, v185
    v_max_f32 v186, s91, v186
    v_max_f32 v187, s91, v187
    v_mfma_f32_16x16x32_bf16 v[128:131], v[72:75], v[112:115], 0
    v_pk_add_f32 v[184:185], v[184:185], v[64:65]
    v_pk_add_f32 v[186:187], v[186:187], v[66:67]
    buffer_load_dwordx4 v14, s[28:31], s64 offen offset:2048 lds
    v_cvt_pk_bf16_f32 v82, v184, v185
    v_cvt_pk_bf16_f32 v83, v186, v187
    v_pk_mul_f32 v[64:65], v[188:189], s[90:91] op_sel_hi:[1,0]
    v_pk_mul_f32 v[66:67], v[190:191], s[90:91] op_sel_hi:[1,0]
    v_exp_f32_e64 v64, v64 clamp
    v_exp_f32_e64 v65, v65 clamp
    v_exp_f32_e64 v66, v66 clamp
    v_exp_f32_e64 v67, v67 clamp
    v_max_f32 v188, s91, v188
    v_max_f32 v189, s91, v189
    v_max_f32 v190, s91, v190
    v_mfma_f32_16x16x32_bf16 v[132:135], v[76:79], v[116:119], 0
    v_max_f32 v191, s91, v191
    v_pk_add_f32 v[188:189], v[188:189], v[64:65]
    v_pk_add_f32 v[190:191], v[190:191], v[66:67]
    v_cvt_pk_bf16_f32 v86, v188, v189
    v_cvt_pk_bf16_f32 v87, v190, v191
    buffer_load_dwordx4 v15, s[28:31], s64 offen offset:3072 lds
    v_cvt_pk_bf16_f32 v120, v208, v209
    v_cvt_pk_bf16_f32 v121, v210, v211
    v_cvt_pk_bf16_f32 v124, v212, v213
    v_cvt_pk_bf16_f32 v125, v214, v215
    v_cvt_pk_bf16_f32 v122, v216, v217
    v_cvt_pk_bf16_f32 v123, v218, v219
    v_cvt_pk_bf16_f32 v126, v220, v221
    v_cvt_pk_bf16_f32 v127, v222, v223
    v_mfma_f32_16x16x32_bf16 v[136:139], v[68:71], v[80:83], v[136:139]
    v_mfma_f32_16x16x32_bf16 v[140:143], v[68:71], v[84:87], v[140:143]
    v_mfma_f32_16x16x32_bf16 v[128:131], v[80:83], v[120:123], v[128:131]
    v_mfma_f32_16x16x32_bf16 v[132:135], v[84:87], v[124:127], v[132:135]
    v_mfma_f32_16x16x32_bf16 v[240:243], v[32:35], a[8:11], 0
    ds_read_b64_tr_b16 v[52:53], v150 offset:12288
    v_mov_b32 v115, s59
    v_mfma_f32_16x16x32_bf16 v[240:243], v[36:39], a[24:27], v[240:243]
    v_mov_b32 v119, s59
    v_mov_b32 v123, s59
    s_nop 0
    v_cndmask_b32 v136, v136, v140, s[72:73]
    s_cmp_eq_u32 s57, 0
    s_cbranch_scc1 L_only2
    ds_write_b128 v89, v[128:131] offset:0
    ds_write_b128 v89, v[132:135] offset:1024
    ds_write_b32 v89, v136 offset:2048
    s_waitcnt lgkmcnt(0)
L_only2:
    s_waitcnt vmcnt(12)
    s_barrier
    v_mfma_f32_16x16x32_bf16 v[248:251], v[36:39], a[28:31], 0
    ds_read_b64_tr_b16 v[54:55], v150 offset:12800
    v_mfma_f32_16x16x32_bf16 v[248:251], v[32:35], a[12:15], v[248:251]
    s_cmp_lg_u32 s57, 0
    s_cbranch_scc1 L_only3
    ds_read_b128 v[72:75], v89 offset:0
    ds_read_b128 v[76:79], v89 offset:1024
    ds_read_b32 v80, v89 offset:2048
    s_waitcnt lgkmcnt(2)
    v_add_f32 v112, v128, v72
    v_add_f32 v113, v129, v73
    v_add_f32 v114, v130, v74
    buffer_store_dwordx4 v[112:115], v88, s[36:39], s86 offen offset:0 sc1
    s_waitcnt lgkmcnt(1)
    v_add_f32 v116, v131, v75
    v_add_f32 v117, v132, v76
    v_add_f32 v118, v133, v77
    buffer_store_dwordx4 v[116:119], v88, s[36:39], s86 offen offset:1024 sc1
    s_waitcnt lgkmcnt(0)
    v_add_f32 v120, v134, v78
    v_add_f32 v121, v135, v79
    v_add_f32 v122, v136, v80
    buffer_store_dwordx4 v[120:123], v88, s[36:39], s86 offen offset:2048 sc1
    s_add_u32 s79, s6, 1867776
    s_mov_b64 exec, 15
    buffer_atomic_swap v1, v29, s[36:39], s79 offen sc1
    s_mov_b64 exec, -1
L_only3:
    s_waitcnt lgkmcnt(4)
    v_mfma_f32_16x16x32_bf16 v[252:255], v[40:43], a[12:15], 0
    ds_read_b64_tr_b16 v[56:57], v151 offset:8192
    v_mfma_f32_16x16x32_bf16 v[252:255], v[44:47], a[28:31], v[252:255]
    v_mfma_f32_16x16x32_bf16 v[244:247], v[44:47], a[24:27], 0
    ds_read_b64_tr_b16 v[58:59], v151 offset:8704
    s_add_u32 m0, s12, 12288
    v_mfma_f32_16x16x32_bf16 v[244:247], v[40:43], a[8:11], v[244:247]
    s_add_u32 s64, s71, 557056
    buffer_load_dwordx4 v12, s[28:31], s64 offen offset:0 lds
    v_lshlrev_b32 v11, 5, v0
    v_mfma_f32_16x16x32_bf16 v[236:239], v[40:43], a[4:7], 0
    ds_read_b64_tr_b16 v[60:61], v151 offset:12288
    v_mfma_f32_16x16x32_bf16 v[236:239], v[44:47], a[20:23], v[236:239]
    v_mfma_f32_16x16x32_bf16 v[228:231], v[44:47], a[16:19], 0
    ds_read_b64_tr_b16 v[62:63], v151 offset:12800
    v_mfma_f32_16x16x32_bf16 v[228:231], v[40:43], a[0:3], v[228:231]
    buffer_load_dwordx4 v13, s[28:31], s64 offen offset:1024 lds
    s_waitcnt lgkmcnt(4)
    v_mfma_f32_16x16x32_bf16 v[224:227], v[48:51], a[32:35], v[224:227]
    ds_read_b64_tr_b16 v[32:33], v150 offset:16384
    v_lshlrev_b32 v20, 3, v0
    v_mfma_f32_16x16x32_bf16 v[224:227], v[52:55], a[48:51], v[224:227]
    v_mfma_f32_16x16x32_bf16 v[232:235], v[52:55], a[52:55], v[232:235]
    ds_read_b64_tr_b16 v[34:35], v150 offset:16896
    v_mfma_f32_16x16x32_bf16 v[232:235], v[48:51], a[36:39], v[232:235]
    v_mfma_f32_16x16x32_bf16 v[240:243], v[48:51], a[40:43], v[240:243]
    ds_read_b64_tr_b16 v[36:37], v150 offset:20480
    v_mfma_f32_16x16x32_bf16 v[240:243], v[52:55], a[56:59], v[240:243]
    buffer_load_dwordx4 v14, s[28:31], s64 offen offset:2048 lds
    v_mfma_f32_16x16x32_bf16 v[248:251], v[52:55], a[60:63], v[248:251]
    ds_read_b64_tr_b16 v[38:39], v150 offset:20992
    v_and_b32 v21, 63, v25
    v_mfma_f32_16x16x32_bf16 v[248:251], v[48:51], a[44:47], v[248:251]
    s_waitcnt lgkmcnt(4)
    v_mfma_f32_16x16x32_bf16 v[252:255], v[56:59], a[44:47], v[252:255]
    ds_read_b64_tr_b16 v[40:41], v151 offset:16384
    v_mfma_f32_16x16x32_bf16 v[252:255], v[60:63], a[60:63], v[252:255]
    buffer_load_dwordx4 v15, s[28:31], s64 offen offset:3072 lds
    v_mfma_f32_16x16x32_bf16 v[244:247], v[60:63], a[56:59], v[244:247]
    ds_read_b64_tr_b16 v[42:43], v151 offset:16896
    v_mfma_f32_16x16x32_bf16 v[244:247], v[56:59], a[40:43], v[244:247]
    v_mfma_f32_16x16x32_bf16 v[236:239], v[56:59], a[36:39], v[236:239]
    ds_read_b64_tr_b16 v[44:45], v151 offset:20480
    v_lshrrev_b32 v26, 4, v0
    v_mfma_f32_16x16x32_bf16 v[236:239], v[60:63], a[52:55], v[236:239]
    v_mfma_f32_16x16x32_bf16 v[228:231], v[60:63], a[48:51], v[228:231]
    ds_read_b64_tr_b16 v[46:47], v151 offset:20992
    s_add_u32 m0, s12, 16384
    v_mfma_f32_16x16x32_bf16 v[228:231], v[56:59], a[32:35], v[228:231]
    s_add_u32 s64, s71, 720896
    buffer_load_dwordx4 v12, s[28:31], s64 offen offset:0 lds
    s_waitcnt lgkmcnt(4)
    v_mfma_f32_16x16x32_bf16 v[224:227], v[32:35], a[64:67], v[224:227]
    ds_read_b64_tr_b16 v[48:49], v150 offset:24576
    v_lshlrev_b32 v10, 7, v26
    v_mfma_f32_16x16x32_bf16 v[224:227], v[36:39], a[80:83], v[224:227]
    v_mfma_f32_16x16x32_bf16 v[232:235], v[36:39], a[84:87], v[232:235]
    ds_read_b64_tr_b16 v[50:51], v150 offset:25088
    v_mfma_f32_16x16x32_bf16 v[232:235], v[32:35], a[68:71], v[232:235]
    buffer_load_dwordx4 v13, s[28:31], s64 offen offset:1024 lds
    v_mfma_f32_16x16x32_bf16 v[240:243], v[32:35], a[72:75], v[240:243]
    ds_read_b64_tr_b16 v[52:53], v150 offset:28672
    v_mfma_f32_16x16x32_bf16 v[240:243], v[36:39], a[88:91], v[240:243]
    v_mfma_f32_16x16x32_bf16 v[248:251], v[36:39], a[92:95], v[248:251]
    ds_read_b64_tr_b16 v[54:55], v150 offset:29184
    v_mul_u32_u24 v26, 1920, v26
    v_mfma_f32_16x16x32_bf16 v[248:251], v[32:35], a[76:79], v[248:251]
    s_waitcnt lgkmcnt(4)
    v_mfma_f32_16x16x32_bf16 v[252:255], v[40:43], a[76:79], v[252:255]
    ds_read_b64_tr_b16 v[56:57], v151 offset:24576
    v_mfma_f32_16x16x32_bf16 v[252:255], v[44:47], a[92:95], v[252:255]
    buffer_load_dwordx4 v14, s[28:31], s64 offen offset:2048 lds
    v_mfma_f32_16x16x32_bf16 v[244:247], v[44:47], a[88:91], v[244:247]
    ds_read_b64_tr_b16 v[58:59], v151 offset:25088
    v_mfma_f32_16x16x32_bf16 v[244:247], v[40:43], a[72:75], v[244:247]
    v_mfma_f32_16x16x32_bf16 v[236:239], v[40:43], a[68:71], v[236:239]
    ds_read_b64_tr_b16 v[60:61], v151 offset:28672
    v_lshl_add_u32 v26, v0, 3, v26
    v_mfma_f32_16x16x32_bf16 v[236:239], v[44:47], a[84:87], v[236:239]
    buffer_load_dwordx4 v15, s[28:31], s64 offen offset:3072 lds
    v_mfma_f32_16x16x32_bf16 v[228:231], v[44:47], a[80:83], v[228:231]
    ds_read_b64_tr_b16 v[62:63], v151 offset:29184
    v_mfma_f32_16x16x32_bf16 v[228:231], v[40:43], a[64:67], v[228:231]
    s_cmp_eq_u32 s57, 0
    s_cbranch_scc1 L_only4
    v_mov_b32 v28, 0
    s_mov_b64 exec, 0xffff
    buffer_atomic_or v28, v25, s[36:39], s7 offen offset:0 sc0 sc1
    s_mov_b64 exec, -1
L_only4:
    s_waitcnt lgkmcnt(4)
    v_mfma_f32_16x16x32_bf16 v[224:227], v[48:51], a[96:99], v[224:227]
    ds_read_b64_tr_b16 v[32:33], v150 offset:32768
    v_mfma_f32_16x16x32_bf16 v[224:227], v[52:55], a[112:115], v[224:227]
    s_waitcnt vmcnt(16)
    ds_read_b64_tr_b16 a[0:1], v16 offset:0
    s_lshl2_add_u32 s88, s55, s3
    ds_read_b64_tr_b16 a[2:3], v16 offset:2048
    v_mfma_f32_16x16x32_bf16 v[232:235], v[52:55], a[116:119], v[232:235]
    ds_read_b64_tr_b16 v[34:35], v150 offset:33280
    s_lshl_b32 s88, s88, 7
    v_mfma_f32_16x16x32_bf16 v[232:235], v[48:51], a[100:103], v[232:235]
    ds_read_b64_tr_b16 a[4:5], v17 offset:0
    v_mfma_f32_16x16x32_bf16 v[240:243], v[48:51], a[104:107], v[240:243]
    ds_read_b64_tr_b16 v[36:37], v150 offset:36864
    ds_read_b64_tr_b16 a[6:7], v17 offset:2048
    v_mfma_f32_16x16x32_bf16 v[240:243], v[52:55], a[120:123], v[240:243]
    s_add_u32 s88, s88, 1835008
    ds_read_b64_tr_b16 a[8:9], v18 offset:0
    v_mfma_f32_16x16x32_bf16 v[248:251], v[52:55], a[124:127], v[248:251]
    ds_read_b64_tr_b16 v[38:39], v150 offset:37376
    s_add_u32 s8, s88, 16384
    v_mfma_f32_16x16x32_bf16 v[248:251], v[48:51], a[108:111], v[248:251]
    ds_read_b64_tr_b16 a[10:11], v18 offset:2048
    ds_read_b64_tr_b16 a[12:13], v19 offset:0
    s_waitcnt lgkmcnt(11)
    v_mfma_f32_16x16x32_bf16 v[252:255], v[56:59], a[108:111], v[252:255]
    ds_read_b64_tr_b16 v[40:41], v151 offset:32768
    s_add_u32 s13, s88, 49152
    v_mfma_f32_16x16x32_bf16 v[252:255], v[60:63], a[124:127], v[252:255]
    ds_read_b64_tr_b16 a[14:15], v19 offset:2048
    v_mfma_f32_16x16x32_bf16 v[244:247], v[60:63], a[120:123], v[244:247]
    ds_read_b64_tr_b16 v[42:43], v151 offset:33280
    s_lshl1_add_u32 s77, s55, s57
    v_mfma_f32_16x16x32_bf16 v[244:247], v[56:59], a[104:107], v[244:247]
    s_add_u32 m0, s12, 20480
    s_add_u32 s64, s71, 917504
    buffer_load_dwordx4 v12, s[28:31], s64 offen offset:0 lds
    buffer_load_dwordx4 v13, s[28:31], s64 offen offset:1024 lds
    s_xor_b32 s78, s77, 1
    v_mfma_f32_16x16x32_bf16 v[236:239], v[56:59], a[100:103], v[236:239]
    ds_read_b64_tr_b16 v[44:45], v151 offset:36864
    v_mfma_f32_16x16x32_bf16 v[236:239], v[60:63], a[116:119], v[236:239]
    buffer_load_dwordx4 v14, s[28:31], s64 offen offset:2048 lds
    s_mul_i32 s67, s77, 181248
    v_mfma_f32_16x16x32_bf16 v[228:231], v[60:63], a[112:115], v[228:231]
    ds_read_b64_tr_b16 v[46:47], v151 offset:37376
    v_mfma_f32_16x16x32_bf16 v[228:231], v[56:59], a[96:99], v[228:231]
    buffer_load_dwordx4 v15, s[28:31], s64 offen offset:3072 lds
    s_waitcnt vmcnt(16)
    ds_read_b64_tr_b16 a[16:17], v16 offset:4096
    s_mul_i32 s68, s78, 181248
    s_waitcnt lgkmcnt(8)
    v_mfma_f32_16x16x32_bf16 v[224:227], v[32:35], a[128:131], v[224:227]
    ds_read_b64_tr_b16 v[48:49], v150 offset:40960
    ds_read_b64_tr_b16 a[18:19], v16 offset:6144
    v_mfma_f32_16x16x32_bf16 v[224:227], v[36:39], a[144:147], v[224:227]
    s_mul_i32 s76, s3, 3072
    ds_read_b64_tr_b16 a[20:21], v17 offset:4096
    v_mfma_f32_16x16x32_bf16 v[232:235], v[36:39], a[148:151], v[232:235]
    ds_read_b64_tr_b16 v[50:51], v150 offset:41472
    ds_read_b64_tr_b16 a[22:23], v17 offset:6144
    v_mfma_f32_16x16x32_bf16 v[232:235], v[32:35], a[132:135], v[232:235]
    s_add_u32 s76, s76, 16777216
    v_mfma_f32_16x16x32_bf16 v[240:243], v[32:35], a[136:139], v[240:243]
    ds_read_b64_tr_b16 v[52:53], v150 offset:45056
    ds_read_b64_tr_b16 a[24:25], v18 offset:4096
    v_mfma_f32_16x16x32_bf16 v[240:243], v[36:39], a[152:155], v[240:243]
    s_add_u32 s67, s67, s76
    ds_read_b64_tr_b16 a[26:27], v18 offset:6144
    v_mfma_f32_16x16x32_bf16 v[248:251], v[36:39], a[156:159], v[248:251]
    ds_read_b64_tr_b16 v[54:55], v150 offset:45568
    ds_read_b64_tr_b16 a[28:29], v19 offset:4096
    v_mfma_f32_16x16x32_bf16 v[248:251], v[32:35], a[140:143], v[248:251]
    s_add_u32 s68, s68, s76
    ds_read_b64_tr_b16 a[30:31], v19 offset:6144
    s_waitcnt lgkmcnt(12)
    v_mfma_f32_16x16x32_bf16 v[252:255], v[40:43], a[140:143], v[252:255]
    ds_read_b64_tr_b16 v[56:57], v151 offset:40960
    s_lshl2_add_u32 s9, s55, s3
    v_mfma_f32_16x16x32_bf16 v[252:255], v[44:47], a[156:159], v[252:255]
    s_add_u32 m0, s12, 0
    s_add_u32 s64, s71, 1081344
    buffer_load_dwordx4 v12, s[28:31], s64 offen offset:0 lds
    v_mfma_f32_16x16x32_bf16 v[244:247], v[44:47], a[152:155], v[244:247]
    ds_read_b64_tr_b16 v[58:59], v151 offset:41472
    v_mfma_f32_16x16x32_bf16 v[244:247], v[40:43], a[136:139], v[244:247]
    buffer_load_dwordx4 v13, s[28:31], s64 offen offset:1024 lds
    s_lshl_b32 s9, s9, 7
    buffer_load_dwordx4 v14, s[28:31], s64 offen offset:2048 lds
    v_mfma_f32_16x16x32_bf16 v[236:239], v[40:43], a[132:135], v[236:239]
    ds_read_b64_tr_b16 v[60:61], v151 offset:45056
    s_add_u32 s9, s9, 16384
    v_mfma_f32_16x16x32_bf16 v[236:239], v[44:47], a[148:151], v[236:239]
    buffer_load_dwordx4 v15, s[28:31], s64 offen offset:3072 lds
    s_waitcnt vmcnt(16)
    ds_read_b64_tr_b16 a[32:33], v16 offset:8192
    v_mfma_f32_16x16x32_bf16 v[228:231], v[44:47], a[144:147], v[228:231]
    ds_read_b64_tr_b16 v[62:63], v151 offset:45568
    s_mul_i32 s76, s58, 1536
    v_mfma_f32_16x16x32_bf16 v[228:231], v[40:43], a[128:131], v[228:231]
    ds_read_b64_tr_b16 a[34:35], v16 offset:10240
    s_waitcnt lgkmcnt(8)
    v_mfma_f32_16x16x32_bf16 v[224:227], v[48:51], a[160:163], v[224:227]
    ds_read_b64_tr_b16 v[32:33], v150 offset:49152
    s_sub_u32 s77, 1536, s76
    v_mfma_f32_16x16x32_bf16 v[224:227], v[52:55], a[176:179], v[224:227]
    ds_read_b64_tr_b16 a[36:37], v17 offset:8192
    ds_read_b64_tr_b16 a[38:39], v17 offset:10240
    v_add_u32 v6, s76, v23
    v_mfma_f32_16x16x32_bf16 v[232:235], v[52:55], a[180:183], v[232:235]
    ds_read_b64_tr_b16 v[34:35], v150 offset:49664
    ds_read_b64_tr_b16 a[40:41], v18 offset:8192
    v_mfma_f32_16x16x32_bf16 v[232:235], v[48:51], a[164:167], v[232:235]
    v_add_u32 v7, s77, v23
    v_mfma_f32_16x16x32_bf16 v[240:243], v[48:51], a[168:171], v[240:243]
    ds_read_b64_tr_b16 v[36:37], v150 offset:53248
    ds_read_b64_tr_b16 a[42:43], v18 offset:10240
    v_mfma_f32_16x16x32_bf16 v[240:243], v[52:55], a[184:187], v[240:243]
    ds_read_b64_tr_b16 a[44:45], v19 offset:8192
    s_lshl_b32 s76, s58, 3
    v_mfma_f32_16x16x32_bf16 v[248:251], v[52:55], a[188:191], v[248:251]
    ds_read_b64_tr_b16 v[38:39], v150 offset:53760
    ds_read_b64_tr_b16 a[46:47], v19 offset:10240
    v_mfma_f32_16x16x32_bf16 v[248:251], v[48:51], a[172:175], v[248:251]
    s_lshl_b32 s10, 0xff, s76
    s_waitcnt lgkmcnt(15)
    s_add_u32 m0, s12, 4096
    s_add_u32 s64, s71, 1277952
    buffer_load_dwordx4 v12, s[28:31], s64 offen offset:0 lds
    s_waitcnt lgkmcnt(11)
    v_mfma_f32_16x16x32_bf16 v[252:255], v[56:59], a[172:175], v[252:255]
    ds_read_b64_tr_b16 v[40:41], v151 offset:49152
    v_mfma_f32_16x16x32_bf16 v[252:255], v[60:63], a[188:191], v[252:255]
    buffer_load_dwordx4 v13, s[28:31], s64 offen offset:1024 lds
    s_add_u32 s76, s76, s57
    v_mfma_f32_16x16x32_bf16 v[244:247], v[60:63], a[184:187], v[244:247]
    ds_read_b64_tr_b16 v[42:43], v151 offset:49664
    v_mfma_f32_16x16x32_bf16 v[244:247], v[56:59], a[168:171], v[244:247]
    buffer_load_dwordx4 v14, s[28:31], s64 offen offset:2048 lds
    s_lshl_b32 s11, 0x55, s76
    buffer_load_dwordx4 v15, s[28:31], s64 offen offset:3072 lds
    s_cmp_eq_u32 s57, 0
    s_cbranch_scc1 L_only5
    s_waitcnt vmcnt(12)
    s_mov_b32 s70, 0
L_h1a_chk:
    v_cmp_ne_u32 vcc, s59, v28
    s_and_b32 s74, vcc_lo, 0xffff
    s_cbranch_scc1 L_h1a_retry
L_h1a_ok:
    buffer_load_dwordx4 v[112:115], v24, s[36:39], s5 offen offset:0 sc1
    buffer_load_dwordx4 v[116:119], v24, s[36:39], s5 offen offset:1024 sc1
    buffer_load_dwordx4 v[120:123], v24, s[36:39], s5 offen offset:2048 sc1
L_only5:
    v_mfma_f32_16x16x32_bf16 v[236:239], v[56:59], a[164:167], v[236:239]
    ds_read_b64_tr_b16 v[44:45], v151 offset:53248
    v_mfma_f32_16x16x32_bf16 v[236:239], v[60:63], a[180:183], v[236:239]
    s_waitcnt vmcnt(16)
    ds_read_b64_tr_b16 a[48:49], v16 offset:12288
    ds_read_b64_tr_b16 a[50:51], v16 offset:14336
    v_mfma_f32_16x16x32_bf16 v[228:231], v[60:63], a[176:179], v[228:231]
    ds_read_b64_tr_b16 v[46:47], v151 offset:53760
    ds_read_b64_tr_b16 a[52:53], v17 offset:12288
    v_mfma_f32_16x16x32_bf16 v[228:231], v[56:59], a[160:163], v[228:231]
    ds_read_b64_tr_b16 a[54:55], v17 offset:14336
    s_waitcnt lgkmcnt(9)
    v_mfma_f32_16x16x32_bf16 v[224:227], v[32:35], a[192:195], v[224:227]
    ds_read_b64_tr_b16 v[48:49], v150 offset:57344
    ds_read_b64_tr_b16 a[56:57], v18 offset:12288
    v_mfma_f32_16x16x32_bf16 v[224:227], v[36:39], a[208:211], v[224:227]
    ds_read_b64_tr_b16 a[58:59], v18 offset:14336
    v_mfma_f32_16x16x32_bf16 v[232:235], v[36:39], a[212:215], v[232:235]
    ds_read_b64_tr_b16 v[50:51], v150 offset:57856
    ds_read_b64_tr_b16 a[60:61], v19 offset:12288
    v_mfma_f32_16x16x32_bf16 v[232:235], v[32:35], a[196:199], v[232:235]
    ds_read_b64_tr_b16 a[62:63], v19 offset:14336
    v_mfma_f32_16x16x32_bf16 v[240:243], v[32:35], a[200:203], v[240:243]
    ds_read_b64_tr_b16 v[52:53], v150 offset:61440
    v_mfma_f32_16x16x32_bf16 v[240:243], v[36:39], a[216:219], v[240:243]
    s_waitcnt lgkmcnt(15)
    s_add_u32 m0, s12, 8192
    s_add_u32 s64, s16, 131072
    buffer_load_dwordx4 v12, s[28:31], s64 offen offset:0 lds
    buffer_load_dwordx4 v13, s[28:31], s64 offen offset:1024 lds
    v_mfma_f32_16x16x32_bf16 v[248:251], v[36:39], a[220:223], v[248:251]
    ds_read_b64_tr_b16 v[54:55], v150 offset:61952
    v_mfma_f32_16x16x32_bf16 v[248:251], v[32:35], a[204:207], v[248:251]
    buffer_load_dwordx4 v14, s[28:31], s64 offen offset:2048 lds
    buffer_load_dwordx4 v15, s[28:31], s64 offen offset:3072 lds
    s_waitcnt lgkmcnt(10)
    v_mfma_f32_16x16x32_bf16 v[252:255], v[40:43], a[204:207], v[252:255]
    ds_read_b64_tr_b16 v[56:57], v151 offset:57344
    v_mfma_f32_16x16x32_bf16 v[252:255], v[44:47], a[220:223], v[252:255]
    s_waitcnt vmcnt(16)
    ds_read_b64_tr_b16 a[64:65], v16 offset:16384
    ds_read_b64_tr_b16 a[66:67], v16 offset:18432
    v_mfma_f32_16x16x32_bf16 v[244:247], v[44:47], a[216:219], v[244:247]
    ds_read_b64_tr_b16 v[58:59], v151 offset:57856
    ds_read_b64_tr_b16 a[68:69], v17 offset:16384
    v_mfma_f32_16x16x32_bf16 v[244:247], v[40:43], a[200:203], v[244:247]
    ds_read_b64_tr_b16 a[70:71], v17 offset:18432
    v_mfma_f32_16x16x32_bf16 v[236:239], v[40:43], a[196:199], v[236:239]
    ds_read_b64_tr_b16 v[60:61], v151 offset:61440
    ds_read_b64_tr_b16 a[72:73], v18 offset:16384
    v_mfma_f32_16x16x32_bf16 v[236:239], v[44:47], a[212:215], v[236:239]
    ds_read_b64_tr_b16 a[74:75], v18 offset:18432
    v_mfma_f32_16x16x32_bf16 v[228:231], v[44:47], a[208:211], v[228:231]
    ds_read_b64_tr_b16 v[62:63], v151 offset:61952
    ds_read_b64_tr_b16 a[76:77], v19 offset:16384
    v_mfma_f32_16x16x32_bf16 v[228:231], v[40:43], a[192:195], v[228:231]
    ds_read_b64_tr_b16 a[78:79], v19 offset:18432
    s_waitcnt lgkmcnt(12)
    v_mfma_f32_16x16x32_bf16 v[224:227], v[48:51], a[224:227], v[224:227]
    s_add_u32 m0, s12, 12288
    s_add_u32 s64, s16, 851968
    v_mfma_f32_16x16x32_bf16 v[224:227], v[52:55], a[240:243], v[224:227]
    buffer_load_dwordx4 v12, s[28:31], s64 offen offset:0 lds
    buffer_load_dwordx4 v13, s[28:31], s64 offen offset:1024 lds
    v_mfma_f32_16x16x32_bf16 v[232:235], v[52:55], a[244:247], v[232:235]
    v_mfma_f32_16x16x32_bf16 v[232:235], v[48:51], a[228:231], v[232:235]
    buffer_load_dwordx4 v14, s[28:31], s64 offen offset:2048 lds
    buffer_load_dwordx4 v15, s[28:31], s64 offen offset:3072 lds
    v_mfma_f32_16x16x32_bf16 v[240:243], v[48:51], a[232:235], v[240:243]
    v_mfma_f32_16x16x32_bf16 v[240:243], v[52:55], a[248:251], v[240:243]
    s_waitcnt vmcnt(16)
    ds_read_b64_tr_b16 a[80:81], v16 offset:20480
    ds_read_b64_tr_b16 a[82:83], v16 offset:22528
    v_mfma_f32_16x16x32_bf16 v[248:251], v[52:55], a[252:255], v[248:251]
    ds_read_b64_tr_b16 a[84:85], v17 offset:20480
    ds_read_b64_tr_b16 a[86:87], v17 offset:22528
    v_mfma_f32_16x16x32_bf16 v[248:251], v[48:51], a[236:239], v[248:251]
    s_waitcnt lgkmcnt(6)
    v_mfma_f32_16x16x32_bf16 v[252:255], v[56:59], a[236:239], v[252:255]
    ds_read_b64_tr_b16 a[88:89], v18 offset:20480
    ds_read_b64_tr_b16 a[90:91], v18 offset:22528
    v_mfma_f32_16x16x32_bf16 v[252:255], v[60:63], a[252:255], v[252:255]
    v_mfma_f32_16x16x32_bf16 v[244:247], v[60:63], a[248:251], v[244:247]
    ds_read_b64_tr_b16 a[92:93], v19 offset:20480
    ds_read_b64_tr_b16 a[94:95], v19 offset:22528
    v_mfma_f32_16x16x32_bf16 v[244:247], v[56:59], a[232:235], v[244:247]
    v_mfma_f32_16x16x32_bf16 v[236:239], v[56:59], a[228:231], v[236:239]
    v_mfma_f32_16x16x32_bf16 v[236:239], v[60:63], a[244:247], v[236:239]
    s_waitcnt lgkmcnt(8)
    s_add_u32 m0, s12, 16384
    s_add_u32 s64, s17, 327680
    buffer_load_dwordx4 v12, s[28:31], s64 offen offset:0 lds
    buffer_load_dwordx4 v13, s[28:31], s64 offen offset:1024 lds
    v_mfma_f32_16x16x32_bf16 v[228:231], v[60:63], a[240:243], v[228:231]
    v_mfma_f32_16x16x32_bf16 v[228:231], v[56:59], a[224:227], v[228:231]
    buffer_load_dwordx4 v14, s[28:31], s64 offen offset:2048 lds
    buffer_load_dwordx4 v15, s[28:31], s64 offen offset:3072 lds
    s_waitcnt vmcnt(16)
    ds_read_b64_tr_b16 a[96:97], v16 offset:0
    ds_read_b64_tr_b16 a[98:99], v16 offset:2048
    ds_read_b64_tr_b16 a[100:101], v17 offset:0
    ds_read_b64_tr_b16 a[102:103], v17 offset:2048
    s_nop 3
    s_cmp_eq_u32 s57, 0
    s_cbranch_scc1 L_only6
    s_waitcnt vmcnt(12)
    s_mov_b32 s70, 0
L_k1a_chk:
    v_xor_b32 v115, s59, v115
    v_bitop3_b32 v115, v119, v1, v115 bitop3:0xbe
    v_bitop3_b32 v115, v123, v1, v115 bitop3:0xbe
    v_cmp_ne_u32 vcc, 0, v115
    s_cbranch_vccnz L_k1a_retry
L_k1a_ok:
    v_mov_b32 v123, v122
    v_permlane32_swap_b32 v112, v117
    v_permlane32_swap_b32 v114, v120
    v_permlane32_swap_b32 v113, v118
    v_permlane32_swap_b32 v116, v121
    v_permlane32_swap_b32 v122, v123
    v_add_f32 v112, v112, v117
    v_add_f32 v114, v114, v120
    v_add_f32 v113, v113, v118
    v_add_f32 v116, v116, v121
    v_add_f32 v122, v122, v123
    v_mov_b32 v123, v122
    v_permlane16_swap_b32 v112, v114
    v_permlane16_swap_b32 v113, v116
    v_permlane16_swap_b32 v122, v123
    v_add_f32 v112, v112, v114
    v_add_f32 v113, v113, v116
    v_add_f32 v122, v122, v123
    v_add_f32_dpp v112, v112, v112 row_ror:4 row_mask:0xf bank_mask:0xf
    v_add_f32_dpp v113, v113, v113 row_ror:4 row_mask:0xf bank_mask:0xf
    v_add_f32_dpp v122, v122, v122 row_ror:4 row_mask:0xf bank_mask:0xf
    v_add_f32_dpp v112, v112, v112 row_ror:8 row_mask:0xf bank_mask:0xf
    v_add_f32_dpp v113, v113, v113 row_ror:8 row_mask:0xf bank_mask:0xf
    v_add_f32_dpp v122, v122, v122 row_ror:8 row_mask:0xf bank_mask:0xf
    v_cvt_pk_bf16_f32 v116, v112, v113
    v_mov_b32 v117, s59
    v_mov_b32_dpp v123, v122 quad_perm:[1,0,3,2] row_mask:0xf bank_mask:0xf
    s_mov_b64 exec, 0x50
    v_cvt_pk_bf16_f32 v116, v122, v123
    s_mov_b64 exec, -1
    ds_bpermute_b32 v116, v90, v116
    s_waitcnt lgkmcnt(0)
    s_mov_b32 exec_hi, 0
    buffer_store_dwordx2 v[116:117], v26, s[36:39], s84 offen sc1
    s_add_u32 s79, s6, 1867840
    s_mov_b64 exec, 15
    buffer_atomic_swap v1, v29, s[36:39], s79 offen sc1
    s_mov_b64 exec, -1
L_only6:
    v_mov_b32 v27, 0
    s_mov_b64 exec, 0xffff
    buffer_atomic_or v27, v25, s[36:39], s88 offen offset:0 sc0 sc1
    s_mov_b64 exec, -1
    ds_read_b64_tr_b16 a[104:105], v18 offset:0
    ds_read_b64_tr_b16 a[106:107], v18 offset:2048
    ds_read_b64_tr_b16 a[108:109], v19 offset:0
    ds_read_b64_tr_b16 a[110:111], v19 offset:2048
    v_pk_mul_f32 v[2:3], v[224:225], s[90:91] op_sel_hi:[1,0]
    v_pk_mul_f32 v[4:5], v[226:227], s[90:91] op_sel_hi:[1,0]
    v_exp_f32_e64 v2, v2 clamp
    v_exp_f32_e64 v3, v3 clamp
    v_exp_f32_e64 v4, v4 clamp
    v_exp_f32_e64 v5, v5 clamp
    v_max_f32 v224, s91, v224
    v_max_f32 v225, s91, v225
    v_max_f32 v226, s91, v226
    v_max_f32 v227, s91, v227
    v_pk_add_f32 v[224:225], v[224:225], v[2:3]
    v_pk_add_f32 v[226:227], v[226:227], v[4:5]
    v_cvt_pk_bf16_f32 v96, v224, v225
    v_cvt_pk_bf16_f32 v97, v226, v227
    s_waitcnt lgkmcnt(8)
    s_add_u32 m0, s12, 20480
    s_add_u32 s64, s71, 0
    buffer_load_dwordx4 v12, s[32:35], s64 offen offset:0 lds
    s_waitcnt vmcnt(14)
    ds_read_b64_tr_b16 a[112:113], v16 offset:4096
    ds_read_b64_tr_b16 a[114:115], v16 offset:6144
    ds_read_b64_tr_b16 a[116:117], v17 offset:4096
    ds_read_b64_tr_b16 a[118:119], v17 offset:6144
    v_pk_mul_f32 v[2:3], v[228:229], s[90:91] op_sel_hi:[1,0]
    v_pk_mul_f32 v[4:5], v[230:231], s[90:91] op_sel_hi:[1,0]
    v_exp_f32_e64 v2, v2 clamp
    v_exp_f32_e64 v3, v3 clamp
    v_exp_f32_e64 v4, v4 clamp
    v_exp_f32_e64 v5, v5 clamp
    v_max_f32 v228, s91, v228
    v_max_f32 v229, s91, v229
    v_max_f32 v230, s91, v230
    v_max_f32 v231, s91, v231
    v_pk_add_f32 v[228:229], v[228:229], v[2:3]
    v_pk_add_f32 v[230:231], v[230:231], v[4:5]
    v_cvt_pk_bf16_f32 v98, v228, v229
    v_cvt_pk_bf16_f32 v99, v230, v231
    buffer_load_dwordx4 v13, s[32:35], s64 offen offset:1024 lds
    ds_read_b64_tr_b16 a[120:121], v18 offset:4096
    ds_read_b64_tr_b16 a[122:123], v18 offset:6144
    ds_read_b64_tr_b16 a[124:125], v19 offset:4096
    ds_read_b64_tr_b16 a[126:127], v19 offset:6144
    v_pk_mul_f32 v[2:3], v[232:233], s[90:91] op_sel_hi:[1,0]
    v_pk_mul_f32 v[4:5], v[234:235], s[90:91] op_sel_hi:[1,0]
    v_exp_f32_e64 v2, v2 clamp
    v_exp_f32_e64 v3, v3 clamp
    v_exp_f32_e64 v4, v4 clamp
    v_exp_f32_e64 v5, v5 clamp
    v_max_f32 v232, s91, v232
    v_max_f32 v233, s91, v233
    v_max_f32 v234, s91, v234
    v_max_f32 v235, s91, v235
    v_pk_add_f32 v[232:233], v[232:233], v[2:3]
    v_pk_add_f32 v[234:235], v[234:235], v[4:5]
    v_cvt_pk_bf16_f32 v100, v232, v233
    v_cvt_pk_bf16_f32 v101, v234, v235
    buffer_load_dwordx4 v14, s[32:35], s64 offen offset:2048 lds
    s_waitcnt vmcnt(12)
    ds_read_b64_tr_b16 a[128:129], v16 offset:8192
    ds_read_b64_tr_b16 a[130:131], v16 offset:10240
    ds_read_b64_tr_b16 a[132:133], v17 offset:8192
    ds_read_b64_tr_b16 a[134:135], v17 offset:10240
    v_pk_mul_f32 v[2:3], v[236:237], s[90:91] op_sel_hi:[1,0]
    v_pk_mul_f32 v[4:5], v[238:239], s[90:91] op_sel_hi:[1,0]
    v_exp_f32_e64 v2, v2 clamp
    v_exp_f32_e64 v3, v3 clamp
    v_exp_f32_e64 v4, v4 clamp
    v_exp_f32_e64 v5, v5 clamp
    v_max_f32 v236, s91, v236
    v_max_f32 v237, s91, v237
    v_max_f32 v238, s91, v238
    v_max_f32 v239, s91, v239
    v_pk_add_f32 v[236:237], v[236:237], v[2:3]
    v_pk_add_f32 v[238:239], v[238:239], v[4:5]
    v_cvt_pk_bf16_f32 v102, v236, v237
    v_cvt_pk_bf16_f32 v103, v238, v239
    buffer_load_dwordx4 v15, s[32:35], s64 offen offset:3072 lds
    ds_read_b64_tr_b16 a[136:137], v18 offset:8192
    ds_read_b64_tr_b16 a[138:139], v18 offset:10240
    ds_read_b64_tr_b16 a[140:141], v19 offset:8192
    ds_read_b64_tr_b16 a[142:143], v19 offset:10240
    v_pk_mul_f32 v[2:3], v[240:241], s[90:91] op_sel_hi:[1,0]
    v_pk_mul_f32 v[4:5], v[242:243], s[90:91] op_sel_hi:[1,0]
    v_exp_f32_e64 v2, v2 clamp
    v_exp_f32_e64 v3, v3 clamp
    v_exp_f32_e64 v4, v4 clamp
    v_exp_f32_e64 v5, v5 clamp
    v_max_f32 v240, s91, v240
    v_max_f32 v241, s91, v241
    v_max_f32 v242, s91, v242
    v_max_f32 v243, s91, v243
    v_pk_add_f32 v[240:241], v[240:241], v[2:3]
    v_pk_add_f32 v[242:243], v[242:243], v[4:5]
    v_cvt_pk_bf16_f32 v104, v240, v241
    v_cvt_pk_bf16_f32 v105, v242, v243
    s_waitcnt lgkmcnt(15)
    s_add_u32 m0, s12, 0
    s_add_u32 s64, s71, 131072
    buffer_load_dwordx4 v12, s[32:35], s64 offen offset:0 lds
    s_waitcnt vmcnt(10)
    ds_read_b64_tr_b16 a[144:145], v16 offset:12288
    ds_read_b64_tr_b16 a[146:147], v16 offset:14336
    ds_read_b64_tr_b16 a[148:149], v17 offset:12288
    ds_read_b64_tr_b16 a[150:151], v17 offset:14336
    v_pk_mul_f32 v[2:3], v[244:245], s[90:91] op_sel_hi:[1,0]
    v_pk_mul_f32 v[4:5], v[246:247], s[90:91] op_sel_hi:[1,0]
    v_exp_f32_e64 v2, v2 clamp
    v_exp_f32_e64 v3, v3 clamp
    v_exp_f32_e64 v4, v4 clamp
    v_exp_f32_e64 v5, v5 clamp
    v_max_f32 v244, s91, v244
    v_max_f32 v245, s91, v245
    v_max_f32 v246, s91, v246
    v_max_f32 v247, s91, v247
    v_pk_add_f32 v[244:245], v[244:245], v[2:3]
    v_pk_add_f32 v[246:247], v[246:247], v[4:5]
    v_cvt_pk_bf16_f32 v106, v244, v245
    v_cvt_pk_bf16_f32 v107, v246, v247
    buffer_load_dwordx4 v13, s[32:35], s64 offen offset:1024 lds
    ds_read_b64_tr_b16 a[152:153], v18 offset:12288
    ds_read_b64_tr_b16 a[154:155], v18 offset:14336
    ds_read_b64_tr_b16 a[156:157], v19 offset:12288
    ds_read_b64_tr_b16 a[158:159], v19 offset:14336
    v_pk_mul_f32 v[2:3], v[248:249], s[90:91] op_sel_hi:[1,0]
    v_pk_mul_f32 v[4:5], v[250:251], s[90:91] op_sel_hi:[1,0]
    v_exp_f32_e64 v2, v2 clamp
    v_exp_f32_e64 v3, v3 clamp
    v_exp_f32_e64 v4, v4 clamp
    v_exp_f32_e64 v5, v5 clamp
    v_max_f32 v248, s91, v248
    v_max_f32 v249, s91, v249
    v_max_f32 v250, s91, v250
    v_max_f32 v251, s91, v251
    v_pk_add_f32 v[248:249], v[248:249], v[2:3]
    v_pk_add_f32 v[250:251], v[250:251], v[4:5]
    v_cvt_pk_bf16_f32 v108, v248, v249
    v_cvt_pk_bf16_f32 v109, v250, v251
    buffer_load_dwordx4 v14, s[32:35], s64 offen offset:2048 lds
    s_waitcnt vmcnt(8)
    ds_read_b64_tr_b16 a[160:161], v16 offset:16384
    ds_read_b64_tr_b16 a[162:163], v16 offset:18432
    ds_read_b64_tr_b16 a[164:165], v17 offset:16384
    ds_read_b64_tr_b16 a[166:167], v17 offset:18432
    v_pk_mul_f32 v[2:3], v[252:253], s[90:91] op_sel_hi:[1,0]
    v_pk_mul_f32 v[4:5], v[254:255], s[90:91] op_sel_hi:[1,0]
    v_exp_f32_e64 v2, v2 clamp
    v_exp_f32_e64 v3, v3 clamp
    v_exp_f32_e64 v4, v4 clamp
    v_exp_f32_e64 v5, v5 clamp
    v_max_f32 v252, s91, v252
    v_max_f32 v253, s91, v253
    v_max_f32 v254, s91, v254
    v_max_f32 v255, s91, v255
    v_pk_add_f32 v[252:253], v[252:253], v[2:3]
    v_pk_add_f32 v[254:255], v[254:255], v[4:5]
    v_cvt_pk_bf16_f32 v110, v252, v253
    v_cvt_pk_bf16_f32 v111, v254, v255
    buffer_load_dwordx4 v15, s[32:35], s64 offen offset:3072 lds
    ds_read_b64_tr_b16 a[168:169], v18 offset:16384
    ds_read_b64_tr_b16 a[170:171], v18 offset:18432
    ds_read_b64_tr_b16 a[172:173], v19 offset:16384
    ds_read_b64_tr_b16 a[174:175], v19 offset:18432
    v_mov_b32 v28, 0
    s_mov_b64 exec, 0xffff
    buffer_atomic_or v28, v25, s[36:39], s7 offen offset:64 sc0 sc1
    s_mov_b64 exec, -1
    s_waitcnt vmcnt(9)
    s_mov_b32 s70, 0
L_f1a_chk:
    v_cmp_ne_u32 vcc, s59, v27
    s_and_b32 s74, vcc_lo, s10
    s_cbranch_scc1 L_f1a_retry
L_f1a_ok:
    s_add_u32 s80, s67, 0
    buffer_load_dwordx4 v[32:35], v6, s[36:39], s80 offen sc1
    s_add_u32 s81, s67, 12288
    buffer_load_dwordx4 v[36:39], v6, s[36:39], s81 offen sc1
    s_waitcnt lgkmcnt(15)
    s_add_u32 m0, s12, 4096
    s_add_u32 s64, s71, 262144
    buffer_load_dwordx4 v12, s[32:35], s64 offen offset:0 lds
    buffer_load_dwordx4 v[40:43], v7, s[36:39], s80 offen sc1
    buffer_load_dwordx4 v[44:47], v7, s[36:39], s81 offen sc1
    s_waitcnt vmcnt(10)
    ds_read_b64_tr_b16 a[176:177], v16 offset:20480
    ds_read_b64_tr_b16 a[178:179], v16 offset:22528
    ds_read_b64_tr_b16 a[180:181], v17 offset:20480
    ds_read_b64_tr_b16 a[182:183], v17 offset:22528
    buffer_load_dwordx4 v13, s[32:35], s64 offen offset:1024 lds
    ds_read_b64_tr_b16 a[184:185], v18 offset:20480
    ds_read_b64_tr_b16 a[186:187], v18 offset:22528
    ds_read_b64_tr_b16 a[188:189], v19 offset:20480
    ds_read_b64_tr_b16 a[190:191], v19 offset:22528
    s_add_u32 s80, s68, 0
    buffer_load_dwordx4 v[48:51], v6, s[36:39], s80 offen sc1
    s_add_u32 s81, s68, 12288
    buffer_load_dwordx4 v[52:55], v6, s[36:39], s81 offen sc1
    buffer_load_dwordx4 v14, s[32:35], s64 offen offset:2048 lds
    s_waitcnt vmcnt(10)
    ds_read_b64_tr_b16 a[192:193], v16 offset:0
    ds_read_b64_tr_b16 a[194:195], v16 offset:2048
    ds_read_b64_tr_b16 a[196:197], v17 offset:0
    ds_read_b64_tr_b16 a[198:199], v17 offset:2048
    buffer_load_dwordx4 v[56:59], v7, s[36:39], s80 offen sc1
    s_waitcnt vmcnt(10)
    s_mov_b32 s70, 0
L_h2a_chk:
    v_cmp_ne_u32 vcc, s59, v28
    s_and_b32 s74, vcc_lo, 0xffff
    s_cbranch_scc1 L_h2a_retry
L_h2a_ok:
    ds_read_b64_tr_b16 a[200:201], v18 offset:0
    ds_read_b64_tr_b16 a[202:203], v18 offset:2048
    ds_read_b64_tr_b16 a[204:205], v19 offset:0
    ds_read_b64_tr_b16 a[206:207], v19 offset:2048
    buffer_load_dwordx4 v[112:115], v11, s[36:39], s87 offen sc1
    buffer_load_dwordx4 v[116:119], v11, s[36:39], s87 offen offset:16 sc1
    s_waitcnt vmcnt(10)
    v_mfma_f32_16x16x32_bf16 v[128:131], a[0:3], v[32:35], 0
    v_mfma_f32_16x16x32_bf16 v[128:131], a[16:19], v[36:39], v[128:131]
    buffer_load_dwordx4 v[120:123], v10, s[36:39], s87 offen offset:2048 sc1
    v_mfma_f32_16x16x32_bf16 v[132:135], a[20:23], v[36:39], 0
    v_mfma_f32_16x16x32_bf16 v[132:135], a[4:7], v[32:35], v[132:135]
    buffer_load_dwordx4 v[124:127], v10, s[36:39], s87 offen offset:2560 sc1
    v_mfma_f32_16x16x32_bf16 v[136:139], a[8:11], v[32:35], 0
    v_mfma_f32_16x16x32_bf16 v[136:139], a[24:27], v[36:39], v[136:139]
    buffer_load_dwordx2 v[8:9], v20, s[36:39], s85 offen sc1
    v_mfma_f32_16x16x32_bf16 v[140:143], a[28:31], v[36:39], 0
    v_mfma_f32_16x16x32_bf16 v[140:143], a[12:15], v[32:35], v[140:143]
    s_waitcnt vmcnt(10)
    v_mfma_f32_16x16x32_bf16 v[156:159], a[12:15], v[40:43], 0
    v_mfma_f32_16x16x32_bf16 v[156:159], a[28:31], v[44:47], v[156:159]
    buffer_load_dwordx4 v[60:63], v7, s[36:39], s81 offen sc1
    v_mfma_f32_16x16x32_bf16 v[152:155], a[24:27], v[44:47], 0
    v_mfma_f32_16x16x32_bf16 v[152:155], a[8:11], v[40:43], v[152:155]
    buffer_load_dwordx4 v15, s[32:35], s64 offen offset:3072 lds
    v_mfma_f32_16x16x32_bf16 v[148:151], a[4:7], v[40:43], 0
    s_add_u32 s80, s67, 24576
    v_mfma_f32_16x16x32_bf16 v[148:151], a[20:23], v[44:47], v[148:151]
    buffer_load_dwordx4 v[64:67], v6, s[36:39], s80 offen sc1
    v_mfma_f32_16x16x32_bf16 v[144:147], a[16:19], v[44:47], 0
    v_mfma_f32_16x16x32_bf16 v[144:147], a[0:3], v[40:43], v[144:147]
    s_waitcnt vmcnt(10)
    v_mfma_f32_16x16x32_bf16 v[160:163], a[0:3], v[48:51], 0
    s_add_u32 s81, s67, 36864
    v_mfma_f32_16x16x32_bf16 v[160:163], a[16:19], v[52:55], v[160:163]
    buffer_load_dwordx4 v[68:71], v6, s[36:39], s81 offen sc1
    v_mfma_f32_16x16x32_bf16 v[164:167], a[20:23], v[52:55], 0
    s_add_u32 m0, s12, 8192
    s_add_u32 s64, s71, 393216
    v_mfma_f32_16x16x32_bf16 v[164:167], a[4:7], v[48:51], v[164:167]
    buffer_load_dwordx4 v12, s[32:35], s64 offen offset:0 lds
    v_mfma_f32_16x16x32_bf16 v[168:171], a[8:11], v[48:51], 0
    v_mfma_f32_16x16x32_bf16 v[168:171], a[24:27], v[52:55], v[168:171]
    buffer_load_dwordx4 v[72:75], v7, s[36:39], s80 offen sc1
    v_mfma_f32_16x16x32_bf16 v[172:175], a[28:31], v[52:55], 0
    v_mfma_f32_16x16x32_bf16 v[172:175], a[12:15], v[48:51], v[172:175]
    buffer_load_dwordx4 v[76:79], v7, s[36:39], s81 offen sc1
    buffer_load_dwordx4 v13, s[32:35], s64 offen offset:1024 lds
    s_add_u32 s80, s68, 24576
    buffer_load_dwordx4 v[80:83], v6, s[36:39], s80 offen sc1
    s_add_u32 s81, s68, 36864
    buffer_load_dwordx4 v[84:87], v6, s[36:39], s81 offen sc1
    s_waitcnt vmcnt(10)
    s_mov_b32 s70, 0
L_k2a_chk:
    v_xor_b32 v113, s59, v113
    v_bitop3_b32 v113, v115, v1, v113 bitop3:0xbe
    v_bitop3_b32 v113, v117, v1, v113 bitop3:0xbe
    v_bitop3_b32 v113, v119, v1, v113 bitop3:0xbe
    v_bitop3_b32 v113, v121, v1, v113 bitop3:0xbe
    v_bitop3_b32 v113, v123, v1, v113 bitop3:0xbe
    v_bitop3_b32 v113, v125, v1, v113 bitop3:0xbe
    v_bitop3_b32 v113, v127, v1, v113 bitop3:0xbe
    v_bitop3_b32 v113, v9, v1, v113 bitop3:0xbe
    v_cmp_ne_u32 vcc, 0, v113
    s_cbranch_vccnz L_k2a_retry
L_k2a_ok:
    ds_bpermute_b32 v2, v21, v8 offset:0
    ds_bpermute_b32 v3, v21, v8 offset:64
    ds_bpermute_b32 v4, v21, v8 offset:128
    ds_bpermute_b32 v5, v21, v8 offset:192
    v_mov_b32 v113, v114
    v_mov_b32 v117, v118
    v_mov_b32 v121, v122
    v_mov_b32 v125, v126
    v_mfma_f32_16x16x16_bf16 v[192:195], v[112:113], v[96:97], 0
    v_mfma_f32_16x16x16_bf16 v[196:199], v[120:121], v[96:97], 0
    v_mfma_f32_16x16x16_bf16 v[200:203], v[116:117], v[98:99], 0
    v_mfma_f32_16x16x16_bf16 v[204:207], v[124:125], v[98:99], 0
    v_mfma_f32_16x16x16_bf16 v[208:211], v[112:113], v[100:101], 0
    v_mfma_f32_16x16x16_bf16 v[212:215], v[120:121], v[100:101], 0
    v_mfma_f32_16x16x16_bf16 v[216:219], v[116:117], v[102:103], 0
    v_mfma_f32_16x16x16_bf16 v[220:223], v[124:125], v[102:103], 0
    v_mfma_f32_16x16x16_bf16 v[224:227], v[112:113], v[104:105], 0
    v_mfma_f32_16x16x16_bf16 v[228:231], v[120:121], v[104:105], 0
    v_mfma_f32_16x16x16_bf16 v[232:235], v[116:117], v[106:107], 0
    v_mfma_f32_16x16x16_bf16 v[236:239], v[124:125], v[106:107], 0
    v_mfma_f32_16x16x16_bf16 v[240:243], v[112:113], v[108:109], 0
    v_mfma_f32_16x16x16_bf16 v[244:247], v[120:121], v[108:109], 0
    v_mfma_f32_16x16x16_bf16 v[248:251], v[116:117], v[110:111], 0
    v_mfma_f32_16x16x16_bf16 v[252:255], v[124:125], v[110:111], 0
    buffer_load_dwordx4 v[88:91], v7, s[36:39], s80 offen sc1
    s_waitcnt vmcnt(10)
    v_mfma_f32_16x16x32_bf16 v[188:191], a[12:15], v[56:59], 0
    v_mfma_f32_16x16x32_bf16 v[188:191], a[28:31], v[60:63], v[188:191]
    buffer_load_dwordx4 v[92:95], v7, s[36:39], s81 offen sc1
    v_mfma_f32_16x16x32_bf16 v[184:187], a[24:27], v[60:63], 0
    v_mfma_f32_16x16x32_bf16 v[184:187], a[8:11], v[56:59], v[184:187]
    s_waitcnt vmcnt(10)
    ds_read_b64_tr_b16 a[208:209], v16 offset:4096
    v_mfma_f32_16x16x32_bf16 v[180:183], a[4:7], v[56:59], 0
    ds_read_b64_tr_b16 a[210:211], v16 offset:6144
    ds_read_b64_tr_b16 a[212:213], v17 offset:4096
    v_mfma_f32_16x16x32_bf16 v[180:183], a[20:23], v[60:63], v[180:183]
    ds_read_b64_tr_b16 a[214:215], v17 offset:6144
    v_add_f32 v196, s91, v196
    v_mfma_f32_16x16x32_bf16 v[176:179], a[16:19], v[60:63], 0
    v_add_f32 v204, s91, v204
    v_mfma_f32_16x16x32_bf16 v[176:179], a[0:3], v[56:59], v[176:179]
    v_rcp_f32 v196, v196
    v_rcp_f32 v204, v204
    s_waitcnt lgkmcnt(7)
    v_mul_f32 v196, v196, v2
    v_mul_f32 v204, v204, v2
    v_pk_mul_f32 v[192:193], v[192:193], v[196:197] op_sel_hi:[1,0]
    v_pk_mul_f32 v[194:195], v[194:195], v[196:197] op_sel_hi:[1,0]
    v_pk_mul_f32 v[200:201], v[200:201], v[204:205] op_sel_hi:[1,0]
    v_pk_mul_f32 v[202:203], v[202:203], v[204:205] op_sel_hi:[1,0]
    v_cvt_pk_bf16_f32 v96, v192, v193
    v_cvt_pk_bf16_f32 v97, v194, v195
    v_cvt_pk_bf16_f32 v98, v200, v201
    v_cvt_pk_bf16_f32 v99, v202, v203
    buffer_store_dwordx4 v[96:99], v23, s[36:39], s82 offen offset:0 sc1
    ds_read_b64_tr_b16 a[216:217], v18 offset:4096
    ds_read_b64_tr_b16 a[218:219], v18 offset:6144
    ds_read_b64_tr_b16 a[220:221], v19 offset:4096
    ds_read_b64_tr_b16 a[222:223], v19 offset:6144
    v_add_f32 v212, s91, v212
    v_add_f32 v220, s91, v220
    v_rcp_f32 v212, v212
    v_rcp_f32 v220, v220
    s_waitcnt lgkmcnt(10)
    v_mul_f32 v212, v212, v3
    v_mul_f32 v220, v220, v3
    v_pk_mul_f32 v[208:209], v[208:209], v[212:213] op_sel_hi:[1,0]
    v_pk_mul_f32 v[210:211], v[210:211], v[212:213] op_sel_hi:[1,0]
    v_pk_mul_f32 v[216:217], v[216:217], v[220:221] op_sel_hi:[1,0]
    v_pk_mul_f32 v[218:219], v[218:219], v[220:221] op_sel_hi:[1,0]
    v_cvt_pk_bf16_f32 v100, v208, v209
    v_cvt_pk_bf16_f32 v101, v210, v211
    v_cvt_pk_bf16_f32 v102, v216, v217
    v_cvt_pk_bf16_f32 v103, v218, v219
    buffer_store_dwordx4 v[100:103], v23, s[36:39], s82 offen offset:1536 sc1
    s_waitcnt vmcnt(10)
    v_mfma_f32_16x16x32_bf16 v[128:131], a[32:35], v[64:67], v[128:131]
    v_add_f32 v228, s91, v228
    v_add_f32 v236, s91, v236
    v_mfma_f32_16x16x32_bf16 v[128:131], a[48:51], v[68:71], v[128:131]
    v_rcp_f32 v228, v228
    v_mfma_f32_16x16x32_bf16 v[132:135], a[52:55], v[68:71], v[132:135]
    v_rcp_f32 v236, v236
    v_mfma_f32_16x16x32_bf16 v[132:135], a[36:39], v[64:67], v[132:135]
    s_waitcnt lgkmcnt(9)
    v_mul_f32 v228, v228, v4
    v_mfma_f32_16x16x32_bf16 v[136:139], a[40:43], v[64:67], v[136:139]
    v_mul_f32 v236, v236, v4
    v_pk_mul_f32 v[224:225], v[224:225], v[228:229] op_sel_hi:[1,0]
    v_mfma_f32_16x16x32_bf16 v[136:139], a[56:59], v[68:71], v[136:139]
    v_pk_mul_f32 v[226:227], v[226:227], v[228:229] op_sel_hi:[1,0]
    v_pk_mul_f32 v[232:233], v[232:233], v[236:237] op_sel_hi:[1,0]
    v_mfma_f32_16x16x32_bf16 v[140:143], a[60:63], v[68:71], v[140:143]
    v_pk_mul_f32 v[234:235], v[234:235], v[236:237] op_sel_hi:[1,0]
    v_cvt_pk_bf16_f32 v104, v224, v225
    v_mfma_f32_16x16x32_bf16 v[140:143], a[44:47], v[64:67], v[140:143]
    v_cvt_pk_bf16_f32 v105, v226, v227
    v_cvt_pk_bf16_f32 v106, v232, v233
    v_cvt_pk_bf16_f32 v107, v234, v235
    buffer_store_dwordx4 v[104:107], v23, s[36:39], s83 offen offset:0 sc1
    v_add_f32 v244, s91, v244
    v_add_f32 v252, s91, v252
    v_rcp_f32 v244, v244
    v_rcp_f32 v252, v252
    s_waitcnt lgkmcnt(8)
    v_mul_f32 v244, v244, v5
    v_mul_f32 v252, v252, v5
    v_pk_mul_f32 v[240:241], v[240:241], v[244:245] op_sel_hi:[1,0]
    v_pk_mul_f32 v[242:243], v[242:243], v[244:245] op_sel_hi:[1,0]
    v_pk_mul_f32 v[248:249], v[248:249], v[252:253] op_sel_hi:[1,0]
    v_pk_mul_f32 v[250:251], v[250:251], v[252:253] op_sel_hi:[1,0]
    v_cvt_pk_bf16_f32 v108, v240, v241
    v_cvt_pk_bf16_f32 v109, v242, v243
    v_cvt_pk_bf16_f32 v110, v248, v249
    v_cvt_pk_bf16_f32 v111, v250, v251
    buffer_store_dwordx4 v[108:111], v23, s[36:39], s83 offen offset:1536 sc1
    s_add_u32 s80, s67, 49152
    buffer_load_dwordx4 v[32:35], v6, s[36:39], s80 offen sc1
    s_waitcnt vmcnt(10)
    v_mfma_f32_16x16x32_bf16 v[156:159], a[44:47], v[72:75], v[156:159]
    s_add_u32 s81, s67, 61440
    v_mfma_f32_16x16x32_bf16 v[156:159], a[60:63], v[76:79], v[156:159]
    buffer_load_dwordx4 v[36:39], v6, s[36:39], s81 offen sc1
    v_mfma_f32_16x16x32_bf16 v[152:155], a[56:59], v[76:79], v[152:155]
    v_mfma_f32_16x16x32_bf16 v[152:155], a[40:43], v[72:75], v[152:155]
    buffer_load_dwordx4 v14, s[32:35], s64 offen offset:2048 lds
    v_mfma_f32_16x16x32_bf16 v[148:151], a[36:39], v[72:75], v[148:151]
    v_mfma_f32_16x16x32_bf16 v[148:151], a[52:55], v[76:79], v[148:151]
    buffer_load_dwordx4 v[40:43], v7, s[36:39], s80 offen sc1
    v_mfma_f32_16x16x32_bf16 v[144:147], a[48:51], v[76:79], v[144:147]
    v_mfma_f32_16x16x32_bf16 v[144:147], a[32:35], v[72:75], v[144:147]
    s_waitcnt vmcnt(10)
    v_mfma_f32_16x16x32_bf16 v[160:163], a[32:35], v[80:83], v[160:163]
    v_mfma_f32_16x16x32_bf16 v[160:163], a[48:51], v[84:87], v[160:163]
    buffer_load_dwordx4 v[44:47], v7, s[36:39], s81 offen sc1
    v_mfma_f32_16x16x32_bf16 v[164:167], a[52:55], v[84:87], v[164:167]
    v_mfma_f32_16x16x32_bf16 v[164:167], a[36:39], v[80:83], v[164:167]
    buffer_load_dwordx4 v15, s[32:35], s64 offen offset:3072 lds
    v_mfma_f32_16x16x32_bf16 v[168:171], a[40:43], v[80:83], v[168:171]
    v_mfma_f32_16x16x32_bf16 v[168:171], a[56:59], v[84:87], v[168:171]
    v_mfma_f32_16x16x32_bf16 v[172:175], a[60:63], v[84:87], v[172:175]
    v_mfma_f32_16x16x32_bf16 v[172:175], a[44:47], v[80:83], v[172:175]
    s_waitcnt vmcnt(10)
    v_mfma_f32_16x16x32_bf16 v[188:191], a[44:47], v[88:91], v[188:191]
    s_add_u32 s80, s68, 49152
    v_mfma_f32_16x16x32_bf16 v[188:191], a[60:63], v[92:95], v[188:191]
    buffer_load_dwordx4 v[48:51], v6, s[36:39], s80 offen sc1
    v_mfma_f32_16x16x32_bf16 v[184:187], a[56:59], v[92:95], v[184:187]
    s_add_u32 s81, s68, 61440
    v_mfma_f32_16x16x32_bf16 v[184:187], a[40:43], v[88:91], v[184:187]
    buffer_load_dwordx4 v[52:55], v6, s[36:39], s81 offen sc1
    v_mfma_f32_16x16x32_bf16 v[180:183], a[36:39], v[88:91], v[180:183]
    v_mfma_f32_16x16x32_bf16 v[180:183], a[52:55], v[92:95], v[180:183]
    buffer_load_dwordx4 v[56:59], v7, s[36:39], s80 offen sc1
    v_mfma_f32_16x16x32_bf16 v[176:179], a[48:51], v[92:95], v[176:179]
    v_mfma_f32_16x16x32_bf16 v[176:179], a[32:35], v[88:91], v[176:179]
    buffer_load_dwordx4 v[60:63], v7, s[36:39], s81 offen sc1
    s_mov_b64 exec, 0xffff
    buffer_load_dword v27, v25, s[36:39], s13 offen offset:0 sc1
    s_mov_b64 exec, -1
    s_add_u32 s80, s67, 73728
    buffer_load_dwordx4 v[64:67], v6, s[36:39], s80 offen sc1
    s_waitcnt vmcnt(10)
    v_mfma_f32_16x16x32_bf16 v[128:131], a[64:67], v[32:35], v[128:131]
    s_add_u32 s81, s67, 86016
    v_mfma_f32_16x16x32_bf16 v[128:131], a[80:83], v[36:39], v[128:131]
    buffer_load_dwordx4 v[68:71], v6, s[36:39], s81 offen sc1
    v_mfma_f32_16x16x32_bf16 v[132:135], a[84:87], v[36:39], v[132:135]
    s_add_u32 s79, s69, 1851392
    v_mfma_f32_16x16x32_bf16 v[132:135], a[68:71], v[32:35], v[132:135]
    s_mov_b64 exec, 15
    buffer_atomic_swap v1, v29, s[36:39], s79 offen sc1
    s_mov_b64 exec, -1
    v_mfma_f32_16x16x32_bf16 v[136:139], a[72:75], v[32:35], v[136:139]
    v_mfma_f32_16x16x32_bf16 v[136:139], a[88:91], v[36:39], v[136:139]
    v_mfma_f32_16x16x32_bf16 v[140:143], a[92:95], v[36:39], v[140:143]
    v_mfma_f32_16x16x32_bf16 v[140:143], a[76:79], v[32:35], v[140:143]
    s_barrier
    buffer_load_dwordx4 v[72:75], v7, s[36:39], s80 offen sc1
    buffer_load_dwordx4 v[76:79], v7, s[36:39], s81 offen sc1
    s_waitcnt vmcnt(11)
    v_mfma_f32_16x16x32_bf16 v[156:159], a[76:79], v[40:43], v[156:159]
    s_add_u32 s80, s68, 73728
    v_mfma_f32_16x16x32_bf16 v[156:159], a[92:95], v[44:47], v[156:159]
    buffer_load_dwordx4 v[80:83], v6, s[36:39], s80 offen sc1
    v_mfma_f32_16x16x32_bf16 v[152:155], a[88:91], v[44:47], v[152:155]
    v_mfma_f32_16x16x32_bf16 v[152:155], a[72:75], v[40:43], v[152:155]
    s_waitcnt vmcnt(11)
    ds_read_b64_tr_b16 a[224:225], v16 offset:8192
    v_mfma_f32_16x16x32_bf16 v[148:151], a[68:71], v[40:43], v[148:151]
    ds_read_b64_tr_b16 a[226:227], v16 offset:10240
    ds_read_b64_tr_b16 a[228:229], v17 offset:8192
    v_mfma_f32_16x16x32_bf16 v[148:151], a[84:87], v[44:47], v[148:151]
    ds_read_b64_tr_b16 a[230:231], v17 offset:10240
    s_add_u32 s81, s68, 86016
    v_mfma_f32_16x16x32_bf16 v[144:147], a[80:83], v[44:47], v[144:147]
    v_mfma_f32_16x16x32_bf16 v[144:147], a[64:67], v[40:43], v[144:147]
    buffer_load_dwordx4 v[84:87], v6, s[36:39], s81 offen sc1
    ds_read_b64_tr_b16 a[232:233], v18 offset:8192
    ds_read_b64_tr_b16 a[234:235], v18 offset:10240
    ds_read_b64_tr_b16 a[236:237], v19 offset:8192
    ds_read_b64_tr_b16 a[238:239], v19 offset:10240
    buffer_load_dwordx4 v[88:91], v7, s[36:39], s80 offen sc1
    s_waitcnt vmcnt(11)
    v_mfma_f32_16x16x32_bf16 v[160:163], a[64:67], v[48:51], v[160:163]
    v_mfma_f32_16x16x32_bf16 v[160:163], a[80:83], v[52:55], v[160:163]
    buffer_load_dwordx4 v[92:95], v7, s[36:39], s81 offen sc1
    v_mfma_f32_16x16x32_bf16 v[164:167], a[84:87], v[52:55], v[164:167]
    v_mfma_f32_16x16x32_bf16 v[164:167], a[68:71], v[48:51], v[164:167]
    v_mfma_f32_16x16x32_bf16 v[168:171], a[72:75], v[48:51], v[168:171]
    v_mfma_f32_16x16x32_bf16 v[168:171], a[88:91], v[52:55], v[168:171]
    v_mfma_f32_16x16x32_bf16 v[172:175], a[92:95], v[52:55], v[172:175]
    v_mfma_f32_16x16x32_bf16 v[172:175], a[76:79], v[48:51], v[172:175]
    s_waitcnt vmcnt(9)
    s_mov_b32 s70, 0
L_f2a_chk:
    v_cmp_ne_u32 vcc, s59, v27
    s_and_b32 s74, vcc_lo, 0xffff
    s_cbranch_scc1 L_f2a_retry
L_f2a_ok:
    v_and_b32 v26, 15, v0
    v_lshlrev_b32 v26, 3, v26
    s_xor_b32 s78, s9, 0
    buffer_load_dword v20, v26, s[36:39], s78 offen sc1
    v_mfma_f32_16x16x32_bf16 v[188:191], a[76:79], v[56:59], v[188:191]
    s_xor_b32 s78, s9, 128
    v_mfma_f32_16x16x32_bf16 v[188:191], a[92:95], v[60:63], v[188:191]
    buffer_load_dword v21, v26, s[36:39], s78 offen sc1
    v_mfma_f32_16x16x32_bf16 v[184:187], a[88:91], v[60:63], v[184:187]
    s_xor_b32 s78, s9, 256
    v_mfma_f32_16x16x32_bf16 v[184:187], a[72:75], v[56:59], v[184:187]
    buffer_load_dword v22, v26, s[36:39], s78 offen sc1
    v_mfma_f32_16x16x32_bf16 v[180:183], a[68:71], v[56:59], v[180:183]
    s_xor_b32 s78, s9, 384
    v_mfma_f32_16x16x32_bf16 v[180:183], a[84:87], v[60:63], v[180:183]
    buffer_load_dword v30, v26, s[36:39], s78 offen sc1
    v_mfma_f32_16x16x32_bf16 v[176:179], a[80:83], v[60:63], v[176:179]
    v_mfma_f32_16x16x32_bf16 v[176:179], a[64:67], v[56:59], v[176:179]
    s_waitcnt vmcnt(11)
    v_mfma_f32_16x16x32_bf16 v[128:131], a[96:99], v[64:67], v[128:131]
    s_add_u32 s80, s68, 98304
    v_mfma_f32_16x16x32_bf16 v[128:131], a[112:115], v[68:71], v[128:131]
    buffer_load_dwordx4 v[32:35], v7, s[36:39], s80 offen sc1
    v_mfma_f32_16x16x32_bf16 v[132:135], a[116:119], v[68:71], v[132:135]
    s_add_u32 s81, s68, 110592
    v_mfma_f32_16x16x32_bf16 v[132:135], a[100:103], v[64:67], v[132:135]
    buffer_load_dwordx4 v[36:39], v7, s[36:39], s81 offen sc1
    v_mfma_f32_16x16x32_bf16 v[136:139], a[104:107], v[64:67], v[136:139]
    v_mfma_f32_16x16x32_bf16 v[136:139], a[120:123], v[68:71], v[136:139]
    v_mfma_f32_16x16x32_bf16 v[140:143], a[124:127], v[68:71], v[140:143]
    v_mfma_f32_16x16x32_bf16 v[140:143], a[108:111], v[64:67], v[140:143]
    s_waitcnt vmcnt(10)
    v_mfma_f32_16x16x32_bf16 v[156:159], a[108:111], v[72:75], v[156:159]
    s_add_u32 s80, s68, 122880
    s_cmp_eq_u32 s3, 3
    v_mfma_f32_16x16x32_bf16 v[156:159], a[124:127], v[76:79], v[156:159]
    s_cselect_b32 s80, 1073741824, s80
    buffer_load_dwordx4 v[40:43], v7, s[36:39], s80 offen sc1
    v_mfma_f32_16x16x32_bf16 v[152:155], a[120:123], v[76:79], v[152:155]
    s_add_u32 s80, s68, 98304
    v_mfma_f32_16x16x32_bf16 v[152:155], a[104:107], v[72:75], v[152:155]
    buffer_load_dwordx4 v[44:47], v6, s[36:39], s80 offen sc1
    v_mfma_f32_16x16x32_bf16 v[148:151], a[100:103], v[72:75], v[148:151]
    v_mfma_f32_16x16x32_bf16 v[148:151], a[116:119], v[76:79], v[148:151]
    v_mfma_f32_16x16x32_bf16 v[144:147], a[112:115], v[76:79], v[144:147]
    v_mfma_f32_16x16x32_bf16 v[144:147], a[96:99], v[72:75], v[144:147]
    s_waitcnt vmcnt(10)
    v_mov_b32 v122, s3
    v_mfma_f32_16x16x32_bf16 v[160:163], a[96:99], v[80:83], v[160:163]
    v_mov_b32 v28, 0
    v_lshl_add_u32 v8, v122, 14, v24
    v_mfma_f32_16x16x32_bf16 v[160:163], a[112:115], v[84:87], v[160:163]
    s_mov_b64 exec, 0xffff
    buffer_atomic_or v28, v25, s[36:39], s8 offen offset:0 sc0 sc1
    s_mov_b64 exec, -1
    v_mfma_f32_16x16x32_bf16 v[164:167], a[116:119], v[84:87], v[164:167]
    s_add_u32 s81, s68, 110592
    v_xor_b32 v10, 32768, v8
    v_mfma_f32_16x16x32_bf16 v[164:167], a[100:103], v[80:83], v[164:167]
    buffer_load_dwordx4 v[48:51], v6, s[36:39], s81 offen sc1
    v_mfma_f32_16x16x32_bf16 v[168:171], a[104:107], v[80:83], v[168:171]
    v_add_u32 v8, 98304, v8
    v_add_u32 v10, 98304, v10
    v_mfma_f32_16x16x32_bf16 v[168:171], a[120:123], v[84:87], v[168:171]
    v_xor_b32 v9, 16384, v8
    v_xor_b32 v11, 16384, v10
    v_mfma_f32_16x16x32_bf16 v[172:175], a[124:127], v[84:87], v[172:175]
    v_lshl_add_u32 v122, s55, 2, v122
    v_lshrrev_b32 v121, 3, v0
    v_mfma_f32_16x16x32_bf16 v[172:175], a[108:111], v[80:83], v[172:175]
    s_waitcnt vmcnt(10)
    v_lshl_add_u32 v29, v122, 4, v121
    v_mfma_f32_16x16x32_bf16 v[188:191], a[108:111], v[88:91], v[188:191]
    s_add_u32 s80, s68, 122880
    s_cmp_eq_u32 s3, 3
    v_mfma_f32_16x16x32_bf16 v[188:191], a[124:127], v[92:95], v[188:191]
    s_cselect_b32 s80, 1073741824, s80
    buffer_load_dwordx4 v[52:55], v6, s[36:39], s80 offen sc1
    v_mfma_f32_16x16x32_bf16 v[184:187], a[120:123], v[92:95], v[184:187]
    s_add_u32 s80, s67, 98304
    v_lshl_add_u32 v29, v29, 3, s56
    v_mfma_f32_16x16x32_bf16 v[184:187], a[104:107], v[88:91], v[184:187]
    buffer_load_dwordx4 v[56:59], v7, s[36:39], s80 offen sc1
    v_mfma_f32_16x16x32_bf16 v[180:183], a[100:103], v[88:91], v[180:183]
    s_add_u32 s81, s67, 110592
    v_lshlrev_b32 v29, 7, v29
    v_mfma_f32_16x16x32_bf16 v[180:183], a[116:119], v[92:95], v[180:183]
    buffer_load_dwordx4 v[60:63], v7, s[36:39], s81 offen sc1
    v_mfma_f32_16x16x32_bf16 v[176:179], a[112:115], v[92:95], v[176:179]
    s_add_u32 s80, s67, 122880
    s_cmp_eq_u32 s3, 3
    v_mfma_f32_16x16x32_bf16 v[176:179], a[96:99], v[88:91], v[176:179]
    s_cselect_b32 s80, 1073741824, s80
    buffer_load_dwordx4 v[64:67], v7, s[36:39], s80 offen sc1
    s_add_u32 s80, s67, 98304
    buffer_load_dwordx4 v[68:71], v6, s[36:39], s80 offen sc1
    s_waitcnt vmcnt(8)
    v_mfma_f32_16x16x32_bf16 v[188:191], a[140:143], v[32:35], v[188:191]
    s_add_u32 s81, s67, 110592
    v_and_b32 v122, 7, v0
    v_mfma_f32_16x16x32_bf16 v[188:191], a[156:159], v[36:39], v[188:191]
    v_lshl_add_u32 v29, v122, 4, v29
    v_lshl_add_u32 v121, v121, 4, v8
    v_mfma_f32_16x16x32_bf16 v[188:191], a[172:175], v[40:43], v[188:191]
    buffer_load_dwordx4 v[72:75], v6, s[36:39], s81 offen sc1
    v_mfma_f32_16x16x32_bf16 v[184:187], a[168:171], v[40:43], v[184:187]
    s_add_u32 s80, s67, 122880
    s_cmp_eq_u32 s3, 3
    v_mfma_f32_16x16x32_bf16 v[184:187], a[152:155], v[36:39], v[184:187]
    s_cselect_b32 s80, 1073741824, s80
    v_add_u32 v121, 12288, v121
    v_mfma_f32_16x16x32_bf16 v[184:187], a[136:139], v[32:35], v[184:187]
    buffer_load_dwordx4 v[76:79], v6, s[36:39], s80 offen sc1
    v_mfma_f32_16x16x32_bf16 v[180:183], a[132:135], v[32:35], v[180:183]
    v_and_b32 v122, 15, v0
    v_lshl_add_u32 v123, v122, 7, v8
    v_mfma_f32_16x16x32_bf16 v[180:183], a[148:151], v[36:39], v[180:183]
    v_lshrrev_b32 v122, 4, v0
    v_mul_u32_u24 v122, 248, v122
    v_mfma_f32_16x16x32_bf16 v[180:183], a[164:167], v[40:43], v[180:183]
    v_sub_u32 v123, v123, v122
    v_add_u32 v123, 12288, v123
    v_mfma_f32_16x16x32_bf16 v[176:179], a[160:163], v[40:43], v[176:179]
    v_mfma_f32_16x16x32_bf16 v[176:179], a[144:147], v[36:39], v[176:179]
    v_mfma_f32_16x16x32_bf16 v[176:179], a[128:131], v[32:35], v[176:179]
    s_waitcnt vmcnt(8)
    s_mov_b32 s70, 0
L_paa_chk:
    v_cmp_ne_u32 vcc, s59, v28
    s_and_b32 s74, vcc_lo, s11
    s_cbranch_scc1 L_paa_retry
L_paa_ok:
    s_add_u32 s80, s68, 132096
    buffer_load_dwordx4 v[80:83], v7, s[36:39], s80 offen sc1
    s_add_u32 s80, s68, 144384
    buffer_load_dwordx4 v[84:87], v7, s[36:39], s80 offen sc1
    s_waitcnt vmcnt(8)
    v_mfma_f32_16x16x32_bf16 v[160:163], a[128:131], v[44:47], v[160:163]
    s_add_u32 s80, s68, 156672
    v_sub_f32 v26, 1.0, v30
    v_mfma_f32_16x16x32_bf16 v[160:163], a[144:147], v[48:51], v[160:163]
    v_mul_f32 v191, v191, v26
    v_mul_f32 v190, v190, v26
    v_mfma_f32_16x16x32_bf16 v[160:163], a[160:163], v[52:55], v[160:163]
    buffer_load_dwordx4 v[88:91], v7, s[36:39], s80 offen sc1
    v_mfma_f32_16x16x32_bf16 v[164:167], a[164:167], v[52:55], v[164:167]
    s_add_u32 s80, s68, 168960
    v_mul_f32 v189, v189, v26
    v_mfma_f32_16x16x32_bf16 v[164:167], a[148:151], v[48:51], v[164:167]
    v_mul_f32 v188, v188, v26
    v_mul_f32 v187, v187, v26
    v_mfma_f32_16x16x32_bf16 v[164:167], a[132:135], v[44:47], v[164:167]
    buffer_load_dwordx4 v[92:95], v7, s[36:39], s80 offen sc1
    v_mfma_f32_16x16x32_bf16 v[168:171], a[136:139], v[44:47], v[168:171]
    s_add_u32 s80, s68, 132096
    v_mul_f32 v186, v186, v26
    v_mfma_f32_16x16x32_bf16 v[168:171], a[152:155], v[48:51], v[168:171]
    v_mul_f32 v185, v185, v26
    v_mul_f32 v184, v184, v26
    v_mfma_f32_16x16x32_bf16 v[168:171], a[168:171], v[52:55], v[168:171]
    buffer_load_dwordx4 v[32:35], v6, s[36:39], s80 offen sc1
    v_mfma_f32_16x16x32_bf16 v[172:175], a[172:175], v[52:55], v[172:175]
    v_mul_f32 v183, v183, v26
    v_mul_f32 v182, v182, v26
    v_mfma_f32_16x16x32_bf16 v[172:175], a[156:159], v[48:51], v[172:175]
    v_mul_f32 v181, v181, v26
    v_mul_f32 v180, v180, v26
    v_mfma_f32_16x16x32_bf16 v[172:175], a[140:143], v[44:47], v[172:175]
    s_waitcnt vmcnt(8)
    v_mul_f32 v179, v179, v26
    v_mfma_f32_16x16x32_bf16 v[156:159], a[140:143], v[56:59], v[156:159]
    s_add_u32 s80, s68, 144384
    v_mul_f32 v178, v178, v26
    v_mfma_f32_16x16x32_bf16 v[156:159], a[156:159], v[60:63], v[156:159]
    v_mul_f32 v177, v177, v26
    v_mul_f32 v176, v176, v26
    v_mfma_f32_16x16x32_bf16 v[156:159], a[172:175], v[64:67], v[156:159]
    buffer_load_dwordx4 v[36:39], v6, s[36:39], s80 offen sc1
    v_mfma_f32_16x16x32_bf16 v[152:155], a[168:171], v[64:67], v[152:155]
    s_add_u32 s80, s68, 156672
    v_sub_f32 v26, 1.0, v22
    v_mfma_f32_16x16x32_bf16 v[152:155], a[152:155], v[60:63], v[152:155]
    v_mul_f32 v160, v160, v26
    v_mul_f32 v161, v161, v26
    v_mfma_f32_16x16x32_bf16 v[152:155], a[136:139], v[56:59], v[152:155]
    buffer_load_dwordx4 v[40:43], v6, s[36:39], s80 offen sc1
    v_mfma_f32_16x16x32_bf16 v[148:151], a[132:135], v[56:59], v[148:151]
    s_add_u32 s80, s68, 168960
    v_mul_f32 v162, v162, v26
    v_mfma_f32_16x16x32_bf16 v[148:151], a[148:151], v[60:63], v[148:151]
    v_mul_f32 v163, v163, v26
    v_mul_f32 v164, v164, v26
    v_mfma_f32_16x16x32_bf16 v[148:151], a[164:167], v[64:67], v[148:151]
    buffer_load_dwordx4 v[44:47], v6, s[36:39], s80 offen sc1
    v_mfma_f32_16x16x32_bf16 v[144:147], a[160:163], v[64:67], v[144:147]
    v_mul_f32 v165, v165, v26
    v_mul_f32 v166, v166, v26
    v_mfma_f32_16x16x32_bf16 v[144:147], a[144:147], v[60:63], v[144:147]
    v_mul_f32 v167, v167, v26
    v_mul_f32 v168, v168, v26
    v_mfma_f32_16x16x32_bf16 v[144:147], a[128:131], v[56:59], v[144:147]
    s_waitcnt vmcnt(8)
    v_mul_f32 v169, v169, v26
    v_mfma_f32_16x16x32_bf16 v[128:131], a[128:131], v[68:71], v[128:131]
    s_add_u32 s80, s67, 132096
    v_mul_f32 v170, v170, v26
    v_mfma_f32_16x16x32_bf16 v[128:131], a[144:147], v[72:75], v[128:131]
    v_mul_f32 v171, v171, v26
    v_mul_f32 v172, v172, v26
    v_mfma_f32_16x16x32_bf16 v[128:131], a[160:163], v[76:79], v[128:131]
    buffer_load_dwordx4 v[48:51], v7, s[36:39], s80 offen sc1
    v_mfma_f32_16x16x32_bf16 v[132:135], a[164:167], v[76:79], v[132:135]
    s_add_u32 s80, s67, 144384
    v_mul_f32 v173, v173, v26
    v_mfma_f32_16x16x32_bf16 v[132:135], a[148:151], v[72:75], v[132:135]
    v_mul_f32 v174, v174, v26
    v_mul_f32 v175, v175, v26
    v_mfma_f32_16x16x32_bf16 v[132:135], a[132:135], v[68:71], v[132:135]
    buffer_load_dwordx4 v[52:55], v7, s[36:39], s80 offen sc1
    v_mfma_f32_16x16x32_bf16 v[136:139], a[136:139], v[68:71], v[136:139]
    v_sub_f32 v26, 1.0, v21
    v_mul_f32 v159, v159, v26
    v_mfma_f32_16x16x32_bf16 v[136:139], a[152:155], v[72:75], v[136:139]
    v_mul_f32 v158, v158, v26
    v_mul_f32 v157, v157, v26
    v_mfma_f32_16x16x32_bf16 v[136:139], a[168:171], v[76:79], v[136:139]
    v_mul_f32 v156, v156, v26
    v_mul_f32 v155, v155, v26
    v_mfma_f32_16x16x32_bf16 v[140:143], a[172:175], v[76:79], v[140:143]
    v_mul_f32 v154, v154, v26
    v_mul_f32 v153, v153, v26
    v_mfma_f32_16x16x32_bf16 v[140:143], a[156:159], v[72:75], v[140:143]
    v_mul_f32 v152, v152, v26
    v_mul_f32 v151, v151, v26
    v_mfma_f32_16x16x32_bf16 v[140:143], a[140:143], v[68:71], v[140:143]
    s_waitcnt vmcnt(8)
    v_mul_f32 v150, v150, v26
    v_mfma_f32_16x16x32_bf16 v[188:191], a[188:191], v[80:83], v[188:191]
    s_add_u32 s80, s67, 156672
    v_mul_f32 v149, v149, v26
    v_mfma_f32_16x16x32_bf16 v[188:191], a[204:207], v[84:87], v[188:191]
    buffer_load_dwordx4 v[56:59], v7, s[36:39], s80 offen sc1
    v_mfma_f32_16x16x32_bf16 v[184:187], a[200:203], v[84:87], v[184:187]
    s_add_u32 s80, s67, 168960
    v_mul_f32 v148, v148, v26
    v_mfma_f32_16x16x32_bf16 v[184:187], a[184:187], v[80:83], v[184:187]
    buffer_load_dwordx4 v[60:63], v7, s[36:39], s80 offen sc1
    v_mfma_f32_16x16x32_bf16 v[180:183], a[180:183], v[80:83], v[180:183]
    v_mul_f32 v147, v147, v26
    v_mul_f32 v146, v146, v26
    v_mfma_f32_16x16x32_bf16 v[180:183], a[196:199], v[84:87], v[180:183]
    v_mul_f32 v145, v145, v26
    v_mul_f32 v144, v144, v26
    v_mfma_f32_16x16x32_bf16 v[176:179], a[192:195], v[84:87], v[176:179]
    v_sub_f32 v26, 1.0, v20
    v_mul_f32 v128, v128, v26
    v_mfma_f32_16x16x32_bf16 v[176:179], a[176:179], v[80:83], v[176:179]
    s_waitcnt vmcnt(8) lgkmcnt(0)
    v_mul_f32 v129, v129, v26
    v_mfma_f32_16x16x32_bf16 v[188:191], a[220:223], v[88:91], v[188:191]
    s_add_u32 s80, s67, 132096
    v_mul_f32 v130, v130, v26
    v_mfma_f32_16x16x32_bf16 v[188:191], a[236:239], v[92:95], v[188:191]
    buffer_load_dwordx4 v[64:67], v6, s[36:39], s80 offen sc1
    v_mfma_f32_16x16x32_bf16 v[184:187], a[232:235], v[92:95], v[184:187]
    s_add_u32 s80, s67, 144384
    v_mul_f32 v131, v131, v26
    v_mfma_f32_16x16x32_bf16 v[184:187], a[216:219], v[88:91], v[184:187]
    buffer_load_dwordx4 v[68:71], v6, s[36:39], s80 offen sc1
    v_mfma_f32_16x16x32_bf16 v[180:183], a[212:215], v[88:91], v[180:183]
    v_mul_f32 v132, v132, v26
    v_mul_f32 v133, v133, v26
    v_mfma_f32_16x16x32_bf16 v[180:183], a[228:231], v[92:95], v[180:183]
    v_mul_f32 v134, v134, v26
    v_mul_f32 v135, v135, v26
    v_mfma_f32_16x16x32_bf16 v[176:179], a[224:227], v[92:95], v[176:179]
    v_mul_f32 v136, v136, v26
    v_mul_f32 v137, v137, v26
    v_mfma_f32_16x16x32_bf16 v[176:179], a[208:211], v[88:91], v[176:179]
    s_waitcnt vmcnt(8)
    v_mul_f32 v138, v138, v26
    v_mfma_f32_16x16x32_bf16 v[160:163], a[176:179], v[32:35], v[160:163]
    s_add_u32 s80, s67, 156672
    v_mul_f32 v139, v139, v26
    v_mfma_f32_16x16x32_bf16 v[160:163], a[192:195], v[36:39], v[160:163]
    buffer_load_dwordx4 v[72:75], v6, s[36:39], s80 offen sc1
    v_mfma_f32_16x16x32_bf16 v[164:167], a[196:199], v[36:39], v[164:167]
    s_add_u32 s80, s67, 168960
    v_mul_f32 v140, v140, v26
    v_mfma_f32_16x16x32_bf16 v[164:167], a[180:183], v[32:35], v[164:167]
    buffer_load_dwordx4 v[76:79], v6, s[36:39], s80 offen sc1
    v_mfma_f32_16x16x32_bf16 v[168:171], a[184:187], v[32:35], v[168:171]
    v_mul_f32 v141, v141, v26
    v_mul_f32 v142, v142, v26
    v_mfma_f32_16x16x32_bf16 v[168:171], a[200:203], v[36:39], v[168:171]
    v_mul_f32 v143, v143, v26
    ds_write_b128 v11, v[188:191] offset:11264
    v_mfma_f32_16x16x32_bf16 v[172:175], a[204:207], v[36:39], v[172:175]
    v_mfma_f32_16x16x32_bf16 v[172:175], a[188:191], v[32:35], v[172:175]
    s_waitcnt vmcnt(8)
    ds_write_b128 v11, v[184:187] offset:10240
    v_mfma_f32_16x16x32_bf16 v[160:163], a[208:211], v[40:43], v[160:163]
    v_mfma_f32_16x16x32_bf16 v[160:163], a[224:227], v[44:47], v[160:163]
    ds_write_b128 v11, v[180:183] offset:9216
    v_mfma_f32_16x16x32_bf16 v[164:167], a[228:231], v[44:47], v[164:167]
    v_mfma_f32_16x16x32_bf16 v[164:167], a[212:215], v[40:43], v[164:167]
    ds_write_b128 v11, v[176:179] offset:8192
    v_mfma_f32_16x16x32_bf16 v[168:171], a[216:219], v[40:43], v[168:171]
    v_mfma_f32_16x16x32_bf16 v[168:171], a[232:235], v[44:47], v[168:171]
    v_mfma_f32_16x16x32_bf16 v[172:175], a[236:239], v[44:47], v[172:175]
    v_mfma_f32_16x16x32_bf16 v[172:175], a[220:223], v[40:43], v[172:175]
    s_waitcnt vmcnt(6)
    ds_write_b128 v10, v[160:163] offset:4096
    v_mfma_f32_16x16x32_bf16 v[156:159], a[188:191], v[48:51], v[156:159]
    v_mfma_f32_16x16x32_bf16 v[156:159], a[204:207], v[52:55], v[156:159]
    ds_write_b128 v10, v[164:167] offset:5120
    v_mfma_f32_16x16x32_bf16 v[152:155], a[200:203], v[52:55], v[152:155]
    v_mfma_f32_16x16x32_bf16 v[152:155], a[184:187], v[48:51], v[152:155]
    ds_write_b128 v10, v[168:171] offset:6144
    v_mfma_f32_16x16x32_bf16 v[148:151], a[180:183], v[48:51], v[148:151]
    v_mfma_f32_16x16x32_bf16 v[148:151], a[196:199], v[52:55], v[148:151]
    ds_write_b128 v10, v[172:175] offset:7168
    v_mfma_f32_16x16x32_bf16 v[144:147], a[192:195], v[52:55], v[144:147]
    v_mfma_f32_16x16x32_bf16 v[144:147], a[176:179], v[48:51], v[144:147]
    s_waitcnt vmcnt(4)
    v_mfma_f32_16x16x32_bf16 v[156:159], a[220:223], v[56:59], v[156:159]
    v_mfma_f32_16x16x32_bf16 v[156:159], a[236:239], v[60:63], v[156:159]
    v_mfma_f32_16x16x32_bf16 v[152:155], a[232:235], v[60:63], v[152:155]
    v_mfma_f32_16x16x32_bf16 v[152:155], a[216:219], v[56:59], v[152:155]
    v_mfma_f32_16x16x32_bf16 v[148:151], a[212:215], v[56:59], v[148:151]
    v_mfma_f32_16x16x32_bf16 v[148:151], a[228:231], v[60:63], v[148:151]
    v_mfma_f32_16x16x32_bf16 v[144:147], a[224:227], v[60:63], v[144:147]
    v_mfma_f32_16x16x32_bf16 v[144:147], a[208:211], v[56:59], v[144:147]
    s_waitcnt vmcnt(2)
    v_mfma_f32_16x16x32_bf16 v[128:131], a[176:179], v[64:67], v[128:131]
    v_mfma_f32_16x16x32_bf16 v[128:131], a[192:195], v[68:71], v[128:131]
    ds_write_b128 v9, v[156:159] offset:3072
    v_mfma_f32_16x16x32_bf16 v[132:135], a[196:199], v[68:71], v[132:135]
    v_mfma_f32_16x16x32_bf16 v[132:135], a[180:183], v[64:67], v[132:135]
    ds_write_b128 v9, v[152:155] offset:2048
    v_mfma_f32_16x16x32_bf16 v[136:139], a[184:187], v[64:67], v[136:139]
    v_mfma_f32_16x16x32_bf16 v[136:139], a[200:203], v[68:71], v[136:139]
    ds_write_b128 v9, v[148:151] offset:1024
    v_mfma_f32_16x16x32_bf16 v[140:143], a[204:207], v[68:71], v[140:143]
    v_mfma_f32_16x16x32_bf16 v[140:143], a[188:191], v[64:67], v[140:143]
    ds_write_b128 v9, v[144:147] offset:0
    s_waitcnt lgkmcnt(0)
    s_barrier
    s_waitcnt vmcnt(0)
    v_mfma_f32_16x16x32_bf16 v[128:131], a[208:211], v[72:75], v[128:131]
    ds_read_b128 v[96:99], v8 offset:0
    ds_read_b128 v[192:195], v8 offset:4096
    v_mfma_f32_16x16x32_bf16 v[128:131], a[224:227], v[76:79], v[128:131]
    ds_read_b128 v[32:35], v8 offset:8192
    ds_read_b128 v[100:103], v8 offset:1024
    v_mfma_f32_16x16x32_bf16 v[132:135], a[228:231], v[76:79], v[132:135]
    ds_read_b128 v[196:199], v8 offset:5120
    ds_read_b128 v[36:39], v8 offset:9216
    v_mfma_f32_16x16x32_bf16 v[132:135], a[212:215], v[72:75], v[132:135]
    ds_read_b128 v[104:107], v8 offset:2048
    ds_read_b128 v[200:203], v8 offset:6144
    v_mfma_f32_16x16x32_bf16 v[136:139], a[216:219], v[72:75], v[136:139]
    ds_read_b128 v[40:43], v8 offset:10240
    ds_read_b128 v[108:111], v8 offset:3072
    v_mfma_f32_16x16x32_bf16 v[136:139], a[232:235], v[76:79], v[136:139]
    ds_read_b128 v[204:207], v8 offset:7168
    ds_read_b128 v[44:47], v8 offset:11264
    v_mfma_f32_16x16x32_bf16 v[140:143], a[236:239], v[76:79], v[140:143]
    v_mfma_f32_16x16x32_bf16 v[140:143], a[220:223], v[72:75], v[140:143]
    s_waitcnt lgkmcnt(9)
    v_pk_add_f32 v[96:97], v[96:97], v[192:193]
    v_pk_add_f32 v[98:99], v[98:99], v[194:195]
    v_pk_add_f32 v[128:129], v[128:129], v[32:33]
    v_pk_add_f32 v[130:131], v[130:131], v[34:35]
    v_pk_add_f32 v[128:129], v[128:129], v[96:97]
    v_pk_add_f32 v[130:131], v[130:131], v[98:99]
    v_cvt_pk_bf16_f32 v48, v128, v129
    v_cvt_pk_bf16_f32 v49, v130, v131
    ds_write_b64 v123, v[48:49] offset:0
    s_waitcnt lgkmcnt(7)
    v_pk_add_f32 v[100:101], v[100:101], v[196:197]
    v_pk_add_f32 v[102:103], v[102:103], v[198:199]
    v_pk_add_f32 v[132:133], v[132:133], v[36:37]
    v_pk_add_f32 v[134:135], v[134:135], v[38:39]
    v_pk_add_f32 v[132:133], v[132:133], v[100:101]
    v_pk_add_f32 v[134:135], v[134:135], v[102:103]
    v_cvt_pk_bf16_f32 v50, v132, v133
    v_cvt_pk_bf16_f32 v51, v134, v135
    ds_write_b64 v123, v[50:51] offset:32
    s_waitcnt lgkmcnt(5)
    v_pk_add_f32 v[104:105], v[104:105], v[200:201]
    v_pk_add_f32 v[106:107], v[106:107], v[202:203]
    v_pk_add_f32 v[136:137], v[136:137], v[40:41]
    v_pk_add_f32 v[138:139], v[138:139], v[42:43]
    v_pk_add_f32 v[136:137], v[136:137], v[104:105]
    v_pk_add_f32 v[138:139], v[138:139], v[106:107]
    v_cvt_pk_bf16_f32 v52, v136, v137
    v_cvt_pk_bf16_f32 v53, v138, v139
    ds_write_b64 v123, v[52:53] offset:64
    s_waitcnt lgkmcnt(3)
    v_pk_add_f32 v[108:109], v[108:109], v[204:205]
    v_pk_add_f32 v[110:111], v[110:111], v[206:207]
    v_pk_add_f32 v[140:141], v[140:141], v[44:45]
    v_pk_add_f32 v[142:143], v[142:143], v[46:47]
    v_pk_add_f32 v[140:141], v[140:141], v[108:109]
    v_pk_add_f32 v[142:143], v[142:143], v[110:111]
    v_cvt_pk_bf16_f32 v54, v140, v141
    v_cvt_pk_bf16_f32 v55, v142, v143
    ds_write_b64 v123, v[54:55] offset:96
    ds_read_b128 v[56:59], v121 offset:0
    ds_read_b128 v[60:63], v121 offset:1152
    s_movk_i32 s76, 8192
    s_waitcnt lgkmcnt(1)
    buffer_store_dwordx4 v[56:59], v29, s[40:43], 0 offen sc1
    s_waitcnt lgkmcnt(0)
    buffer_store_dwordx4 v[60:63], v29, s[40:43], s76 offen sc1
    s_endpgm
L_h1a_retry:
    s_add_u32 s70, s70, 1
    s_cmp_gt_u32 s70, 0x8000
    s_cbranch_scc1 L_h1a_ok
    v_mov_b32 v28, 0
    s_mov_b64 exec, 0xffff
    buffer_atomic_or v28, v25, s[36:39], s7 offen offset:0 sc0 sc1
    s_mov_b64 exec, -1
    s_waitcnt vmcnt(0)
    s_branch L_h1a_chk
L_k1a_retry:
    s_add_u32 s70, s70, 1
    s_cmp_gt_u32 s70, 0x8000
    s_cbranch_scc1 L_k1a_ok
    buffer_load_dwordx4 v[112:115], v24, s[36:39], s5 offen offset:0 sc1
    buffer_load_dwordx4 v[116:119], v24, s[36:39], s5 offen offset:1024 sc1
    buffer_load_dwordx4 v[120:123], v24, s[36:39], s5 offen offset:2048 sc1
    s_waitcnt vmcnt(0)
    s_branch L_k1a_chk
L_f1a_retry:
    s_add_u32 s70, s70, 1
    s_cmp_gt_u32 s70, 0x8000
    s_cbranch_scc1 L_f1a_ok
    v_mov_b32 v27, 0
    s_mov_b64 exec, 0xffff
    buffer_atomic_or v27, v25, s[36:39], s88 offen offset:0 sc0 sc1
    s_mov_b64 exec, -1
    s_waitcnt vmcnt(0)
    s_branch L_f1a_chk
L_h2a_retry:
    s_add_u32 s70, s70, 1
    s_cmp_gt_u32 s70, 0x8000
    s_cbranch_scc1 L_h2a_ok
    v_mov_b32 v28, 0
    s_mov_b64 exec, 0xffff
    buffer_atomic_or v28, v25, s[36:39], s7 offen offset:64 sc0 sc1
    s_mov_b64 exec, -1
    s_waitcnt vmcnt(0)
    s_branch L_h2a_chk
L_k2a_retry:
    s_add_u32 s70, s70, 1
    s_cmp_gt_u32 s70, 0x8000
    s_cbranch_scc1 L_k2a_ok
    buffer_load_dwordx4 v[112:115], v11, s[36:39], s87 offen sc1
    buffer_load_dwordx4 v[116:119], v11, s[36:39], s87 offen offset:16 sc1
    buffer_load_dwordx4 v[120:123], v10, s[36:39], s87 offen offset:2048 sc1
    buffer_load_dwordx4 v[124:127], v10, s[36:39], s87 offen offset:2560 sc1
    buffer_load_dwordx2 v[8:9], v20, s[36:39], s85 offen sc1
    s_waitcnt vmcnt(0)
    s_branch L_k2a_chk
L_f2a_retry:
    s_add_u32 s70, s70, 1
    s_cmp_gt_u32 s70, 0x8000
    s_cbranch_scc1 L_f2a_ok
    v_mov_b32 v27, 0
    s_mov_b64 exec, 0xffff
    buffer_atomic_or v27, v25, s[36:39], s13 offen offset:0 sc0 sc1
    s_mov_b64 exec, -1
    s_waitcnt vmcnt(0)
    s_branch L_f2a_chk
L_paa_retry:
    s_add_u32 s70, s70, 1
    s_cmp_gt_u32 s70, 0x8000
    s_cbranch_scc1 L_paa_ok
    v_mov_b32 v28, 0
    s_mov_b64 exec, 0xffff
    buffer_atomic_or v28, v25, s[36:39], s8 offen offset:0 sc0 sc1
    s_mov_b64 exec, -1
    s_waitcnt vmcnt(0)
    s_branch L_paa_chk
L_end:
    s_endpgm
.if (. - gated_mix__linear_attn_block__dense_activation_relu__prompt_kernel) < 34048
.fill (34048 - (. - gated_mix__linear_attn_block__dense_activation_relu__prompt_kernel)) / 4, 4, 0xbf810000
.endif
.section .rodata,"a"
.p2align 6
.amdhsa_kernel gated_mix__linear_attn_block__dense_activation_relu__prompt_kernel
  .amdhsa_next_free_vgpr 512
  .amdhsa_next_free_sgpr 102
  .amdhsa_accum_offset 256
  .amdhsa_group_segment_fixed_size 0
  .amdhsa_kernarg_size 80
  .amdhsa_user_sgpr_count 2
  .amdhsa_user_sgpr_kernarg_segment_ptr 1
  .amdhsa_system_sgpr_workgroup_id_x 1
.end_amdhsa_kernel
```
